```python
import torch

def _softmax(x, axis=-1):
    return torch.softmax(x, dim=axis)
def _gelu(x):
    return torch.nn.functional.gelu(x, approximate="tanh")
def _silu(x):
    return torch.nn.functional.silu(x)
def _sigmoid(x):
    return torch.sigmoid(x)
def _layernorm(x, axis=-1, eps=1e-5):
    m = x.mean(dim=axis, keepdim=True)
    v = x.var(dim=axis, keepdim=True, unbiased=False)
    return (x - m) / torch.sqrt(v + eps)
def _scatter_add(tgt, idx, src, axis=0):
    return tgt.clone().index_add_(axis, idx, src)
def _segment_sum(src, seg, n):
    out = torch.zeros((n,) + src.shape[1:], dtype=src.dtype)
    return out.index_add_(0, seg, src)
def _pad(x, pw):
    flat = tuple(v for pair in reversed(pw) for v in pair)
    return torch.nn.functional.pad(x, flat)

kernel_name = 'interleave_layers__spectral_fnet__moe_arch_mod__prompt'

def setup_inputs():

    _w = (lambda a: (lambda t: t.to(torch.bfloat16) if t.is_floating_point() else t)(torch.as_tensor(a)))
    def _A_setup():
        B, S, D = 1, 2048, 512
        ns = torch.arange(S)[:, None] * torch.arange(S)[None, :]
        nd = torch.arange(D)[:, None] * torch.arange(D)[None, :]
        Ws_re = torch.cos(-2.0 * torch.pi * ns / S).to(float)
        Ws_im = torch.sin(-2.0 * torch.pi * ns / S).to(float)
        Wd_re = torch.cos(-2.0 * torch.pi * nd / D).to(float)
        Wd_im = torch.sin(-2.0 * torch.pi * nd / D).to(float)
        return {
            "x": _w((lambda *s: torch.randn(*s, dtype=torch.bfloat16) * 0.05)(B, S, D)),
            "dft_seq_re": _w(Ws_re),
            "dft_seq_im": _w(Ws_im),
            "dft_hid_re": _w(Wd_re),
            "dft_hid_im": _w(Wd_im),
        }
    _A_in = _A_setup()

    def _B_setup():
        B, S, D, F, C = 1, 2048, 512, 1792, 1
        return {
            "x": _w((lambda *s: torch.randn(*s, dtype=torch.bfloat16) * 0.05)(B, S, D)),
            "w_r": _w((lambda *s: torch.randn(*s, dtype=torch.bfloat16) * 1.6)(D)),
            "w_gate": _w((lambda *s: torch.randn(*s, dtype=torch.bfloat16) * 0.4)(D, F)),
            "w_up": _w((lambda *s: torch.randn(*s, dtype=torch.bfloat16) * 0.4)(D, F)),
            "w_down": _w((lambda *s: torch.randn(*s, dtype=torch.bfloat16) * 0.4)(F, D)),
        }
    _B_in = _B_setup()

    return {
        "A_x": _A_in["x"],
        "A_dft_seq_re": _A_in["dft_seq_re"],
        "A_dft_seq_im": _A_in["dft_seq_im"],
        "A_dft_hid_re": _A_in["dft_hid_re"],
        "A_dft_hid_im": _A_in["dft_hid_im"],
        "B_x": _B_in["x"],
        "B_w_r": _B_in["w_r"],
        "B_w_gate": _B_in["w_gate"],
        "B_w_up": _B_in["w_up"],
        "B_w_down": _B_in["w_down"],
    }

def reference(A_x, A_dft_seq_re, A_dft_seq_im, A_dft_hid_re, A_dft_hid_im, B_x, B_w_r, B_w_gate, B_w_up, B_w_down):
    def _A_ref(x, dft_seq_re, dft_seq_im, dft_hid_re, dft_hid_im):
        a = torch.einsum("bsd,ed->bse", x, dft_hid_re)
        b = torch.einsum("bsd,ed->bse", x, dft_hid_im)
        y = torch.einsum("ts,bse->bte", dft_seq_re, a) - torch.einsum("ts,bse->bte", dft_seq_im, b)
        return y

    def _B_ref(x, w_r, w_gate, w_up, w_down):
        B, S, D = x.shape
        C = 1
        r = x @ w_r
        idx = torch.argsort(-r, axis=-1)[:, :C]
        idx_e = (lambda x, n, axis: torch.repeat_interleave(x, n, dim=axis))(idx.reshape(B, C, 1), D, axis=2)
        x_sel = (lambda x, i, axis: torch.take_along_dim(x, i, dim=axis))(x, idx_e, axis=1)
        g = _silu(x_sel @ w_gate)
        u = x_sel @ w_up
        y = (g * u) @ w_down
        r_sel = _sigmoid((lambda x, i, axis: torch.take_along_dim(x, i, dim=axis))(r, idx, axis=1))
        y = y * r_sel.reshape(B, C, 1)
        b_off = (torch.arange(B) * S).reshape(B, 1)
        flat_idx = (idx + b_off).reshape(B * C)
        zero = (x * 0.0).reshape(B * S, D)
        upd = _scatter_add(zero, flat_idx, y.reshape(B * C, D), axis=0)
        return x + upd.reshape(B, S, D)

    x = A_x
    x = x + _A_ref(_layernorm(x, axis=-1), A_dft_seq_re, A_dft_seq_im, A_dft_hid_re, A_dft_hid_im)
    x = x + _B_ref(_layernorm(x, axis=-1), B_w_r, B_w_gate, B_w_up, B_w_down)
    x = x + _A_ref(_layernorm(x, axis=-1), A_dft_seq_re, A_dft_seq_im, A_dft_hid_re, A_dft_hid_im)
    x = x + _B_ref(_layernorm(x, axis=-1), B_w_r, B_w_gate, B_w_up, B_w_down)
    return x
```

```asm
; @launch grid=(253,1,1) block=(512,1,1) lds=149504
.amdgcn_target "amdgcn-amd-amdhsa--gfx950"
.text
.globl interleave_layers__spectral_fnet__moe_arch_mod__prompt_kernel
.p2align 8
.type interleave_layers__spectral_fnet__moe_arch_mod__prompt_kernel,@function
interleave_layers__spectral_fnet__moe_arch_mod__prompt_kernel:
    s_getpc_b64 s[20:21]
    s_cmp_ge_u32 s2, 253
    s_cbranch_scc1 L_end
    s_load_dwordx2 s[4:5], s[0:1], 0
    s_load_dwordx8 s[8:15], s[0:1], 48
    s_load_dwordx2 s[6:7], s[0:1], 96
    s_load_dwordx4 s[16:19], s[0:1], 80
    v_lshrrev_b32 v8, 6, v0
    v_and_b32 v1, 63, v0
    v_readfirstlane_b32 s3, v8
    v_lshlrev_b32 v4, 4, v0
    v_lshlrev_b32 v5, 4, v1
    s_mov_b32 s43, 0x5a17c3e9
    s_cmp_ge_u32 s2, 129
    s_cbranch_scc1 L_notR
    s_add_u32 s56, s20, L_table-interleave_layers__spectral_fnet__moe_arch_mod__prompt_kernel-4+0
    s_addc_u32 s57, s21, 0
    s_lshl_b32 s64, s3, 10
    s_add_u32 m0, s64, 65536
    s_nop 0
    global_load_lds_dwordx4 v4, s[56:57]
    s_lshl_b32 s40, s3, 8
    s_add_u32 s40, s40, s2
    s_sub_u32 s41, 2048, s40
    s_and_b32 s41, s41, 2047
    s_lshl_b32 s64, s40, 10
    s_lshl_b32 s65, s41, 10
    s_mov_b32 s30, 2097152
    s_mov_b32 s31, 0x20000
    s_mul_i32 m0, s3, 3072
    v_and_b32 v9, 16, v1
    v_and_b32 v10, 32, v1
    v_lshlrev_b32 v9, 1, v9
    v_lshl_or_b32 v9, v10, 2, v9
    v_xor_b32 v31, v9, v5
    s_waitcnt lgkmcnt(0)
    s_mov_b64 s[28:29], s[4:5]
    buffer_load_dwordx4 v31, s[28:31], s64 offen  lds
    buffer_load_dwordx4 v[148:151], v5, s[28:31], s65 offen
    s_branch L_R
L_notR:
    s_getreg_b32 s41, hwreg(HW_REG_XCC_ID, 0, 3)
    s_getreg_b32 s64, hwreg(HW_REG_HW_ID, 13, 2)
    s_cmp_eq_u32 s64, 0
    s_cbranch_scc0 L_only_1
    s_cmp_lg_u32 s3, 0
    s_cbranch_scc0 L_only_2
    v_lshlrev_b32 v11, 7, v0
    v_subrev_u32 v11, 8192, v11
    v_min_u32 v11, L_table-interleave_layers__spectral_fnet__moe_arch_mod__prompt_kernel+16376, v11
    global_load_dword v31, v11, s[20:21]
L_only_2:
L_only_1:
    v_lshrrev_b32 v8, 3, v0
    v_and_b32 v9, 7, v0
    v_mul_u32_u24 v10, 3584, v8
    v_lshl_add_u32 v10, v9, 4, v10
    v_mov_b32 v17, 149312
    s_mov_b32 s42, 0
    s_waitcnt lgkmcnt(0)
    s_mov_b64 s[24:25], s[18:19]
    s_mov_b32 s26, 256
    s_mov_b32 s27, 0x20000
L_ticket:
    s_cmp_eq_u32 s3, 0
    s_cbranch_scc0 L_only_3
    s_lshl_b32 s64, s41, 4
    v_mov_b32 v18, s64
    v_mov_b32 v16, 1
    s_mov_b64 exec, 1
    buffer_atomic_add v16, v18, s[24:27], 0 offen sc0
    s_mov_b64 exec, -1
L_only_3:
    s_cmp_eq_u32 s3, 0
    s_cbranch_scc0 L_only_4
    s_waitcnt vmcnt(0)
    s_mov_b64 exec, 1
    ds_write_b32 v17, v16
    s_mov_b64 exec, -1
L_only_4:
    s_waitcnt lgkmcnt(0)
    s_barrier
    ds_read_b32 v16, v17
    s_cmp_lt_u32 s41, 4
    s_cselect_b32 s66, 4, 3
    s_waitcnt lgkmcnt(0)
    v_readfirstlane_b32 s65, v16
    s_barrier
    s_lshl3_add_u32 s40, s65, s41
    s_cmp_lt_u32 s65, s66
    s_cbranch_scc1 L_F
    s_sub_u32 s65, s65, s66
    s_mul_i32 s67, s65, 43
    s_lshr_b32 s67, s67, 7
    s_cmp_lg_u32 s42, 0
    s_cbranch_scc1 L_hnext
    s_cmp_ge_u32 s67, s66
    s_cbranch_scc1 L_hidle
    s_mul_i32 s68, s67, 3
    s_sub_u32 s68, s65, s68
    s_lshl3_add_u32 s69, s67, s41
    s_lshl_b32 s75, s69, 7
    s_mov_b32 s76, 229376
    s_mov_b32 s30, 1835008
    s_mov_b32 s31, 0x20000
    s_cmp_eq_u32 s68, 0
    s_cselect_b64 s[28:29], s[10:11], s[12:13]
    v_mov_b32 v11, v10
    s_cmp_eq_u32 s68, 2
    s_cbranch_scc0 L_only_5
    s_mov_b64 s[28:29], s[14:15]
    s_lshl_b32 s75, s69, 16
    s_add_u32 s75, s75, 57344
    s_mov_b32 s76, -8192
    v_mov_b32 v11, v4
L_only_5:
    buffer_load_dwordx4 v[12:15], v11, s[28:31], s75 offen
    s_add_u32 s75, s75, s76
    buffer_load_dwordx4 v[12:15], v11, s[28:31], s75 offen
    s_add_u32 s75, s75, s76
    buffer_load_dwordx4 v[12:15], v11, s[28:31], s75 offen
    s_add_u32 s75, s75, s76
    buffer_load_dwordx4 v[12:15], v11, s[28:31], s75 offen
    s_add_u32 s75, s75, s76
    buffer_load_dwordx4 v[12:15], v11, s[28:31], s75 offen
    s_add_u32 s75, s75, s76
    buffer_load_dwordx4 v[12:15], v11, s[28:31], s75 offen
    s_add_u32 s75, s75, s76
    buffer_load_dwordx4 v[12:15], v11, s[28:31], s75 offen
    s_add_u32 s75, s75, s76
    buffer_load_dwordx4 v[12:15], v11, s[28:31], s75 offen
L_hidle:
    s_sleep 40
L_hnext:
    s_waitcnt vmcnt(0)
    s_cmp_eq_u32 s3, 0
    s_cbranch_scc0 L_only_6
    v_and_b32 v18, 7, v0
    v_lshlrev_b32 v19, 4, v18
    buffer_load_dword v16, v19, s[24:27], 0 offen sc1
    v_lshrrev_b32 v18, 2, v18
    v_sub_u32 v18, 4, v18
    s_waitcnt vmcnt(0)
    v_cmp_lt_u32 vcc, v16, v18
    s_nop 1
    v_mov_b32 v16, vcc_lo
    ds_write_b32 v17, v16
L_only_6:
    s_waitcnt lgkmcnt(0)
    s_barrier
    ds_read_b32 v16, v17
    s_waitcnt lgkmcnt(0)
    v_readfirstlane_b32 s65, v16
    s_barrier
    s_add_u32 s42, s42, 1
    s_ff1_i32_b32 s41, s65
    s_and_b32 s41, s41, 7
    s_cmp_lg_u32 s65, 0
    s_cbranch_scc1 L_ticket
    s_cmp_eq_u32 s3, 0
    s_cbranch_scc0 L_only_7
    v_mov_b32 v18, 128
    v_mov_b32 v16, 1
    s_mov_b64 exec, 1
    buffer_atomic_add v16, v18, s[24:27], 0 offen sc0
    s_waitcnt vmcnt(0)
    v_readfirstlane_b32 s64, v16
    s_mov_b64 exec, -1
    s_cmp_eq_u32 s64, 95
    s_cbranch_scc0 L_only_8
    v_lshlrev_b32 v18, 2, v1
    v_mov_b32 v16, 0
    buffer_store_dword v16, v18, s[24:27], 0 offen sc1
L_only_8:
L_only_7:
L_hexit:
    s_endpgm
L_F:
    s_lshl_b32 s75, s40, 7
    s_lshl_b32 s76, s40, 16
    s_mov_b64 s[28:29], s[10:11]
    s_mov_b32 s30, 1835008
    s_mov_b32 s31, 0x20000
    s_mov_b64 s[32:33], s[12:13]
    s_mov_b32 s34, 1835008
    s_mov_b32 s35, 0x20000
    s_mov_b64 s[36:37], s[14:15]
    s_mov_b32 s38, 1835008
    s_mov_b32 s39, 0x20000
    buffer_load_dwordx4 v[96:99], v4, s[36:39], s76 offen
    s_addk_i32 s76, 8192
    buffer_load_dwordx4 v[100:103], v4, s[36:39], s76 offen
    s_addk_i32 s76, 8192
    buffer_load_dwordx4 v[104:107], v4, s[36:39], s76 offen
    s_addk_i32 s76, 8192
    buffer_load_dwordx4 v[108:111], v4, s[36:39], s76 offen
    s_addk_i32 s76, 8192
    buffer_load_dwordx4 v[112:115], v4, s[36:39], s76 offen
    s_addk_i32 s76, 8192
    buffer_load_dwordx4 v[116:119], v4, s[36:39], s76 offen
    s_addk_i32 s76, 8192
    buffer_load_dwordx4 v[120:123], v4, s[36:39], s76 offen
    s_addk_i32 s76, 8192
    buffer_load_dwordx4 v[124:127], v4, s[36:39], s76 offen
    s_branch L_F2
.p2align 6
L_R:
    s_mov_b64 s[36:37], s[8:9]
    s_mov_b32 s38, 1024
    s_mov_b32 s39, 0x20000
    s_mov_b64 s[24:25], s[6:7]
    s_mov_b32 s26, 33554432
    s_mov_b32 s27, 0x20000
    s_mov_b64 s[32:33], s[16:17]
    s_mov_b32 s34, 2097152
    s_mov_b32 s35, 0x20000
    v_mov_b32 v140, -1
    v_mov_b32 v141, -1
    v_mov_b32 v142, -1
    v_mov_b32 v143, -1
    v_and_b32 v2, 15, v0
    v_lshrrev_b32 v3, 4, v1
    v_and_b32 v11, 3, v0
    v_bfe_u32 v12, v0, 2, 6
    v_and_b32 v4, 0xfff, v4
    v_mul_u32_u24 v234, 8320, v12
    v_lshlrev_b32 v13, 4, v11
    s_lshl_b32 s66, s2, 6
    v_add3_u32 v234, v234, v13, s66
    v_mul_u32_u24 v235, 8192, v12
    s_add_u32 s66, s66, 2514944
    v_add3_u32 v235, v235, v13, s66
    s_mul_i32 s77, s2, 8320
    s_mul_i32 s78, s2, 8192
    s_add_u32 s78, s78, 2514944
    s_add_u32 s79, s77, 4096
    s_add_u32 s80, s78, 4096
    s_mov_b32 s81, 532480
    s_mov_b32 s82, 524288
    v_add_u32 v253, 65536, v5
    s_mov_b32 s74, 0x42000000
    s_and_b32 s66, s2, 127
    s_mov_b32 s42, 0x38003800
    s_cselect_b32 s42, 0x3c003c00, s42
    s_mov_b64 s[58:59], 1
    s_mov_b32 s60, 0x10002
    s_mov_b32 s61, 0x30001
    s_mov_b32 s62, 0x20003
    s_mov_b32 s63, 0x1
    v_mov_b32 v249, 0xfffcfffc
    v_mov_b32 v76, 0xbc003c00
    v_mov_b32 v77, 0xbc003c00
    v_mov_b32 v78, 0
    v_mov_b32 v79, 0
    s_mul_i32 s66, s3, 3072
    v_add_u32 v229, s66, v5
    s_add_u32 s67, s66, 1024
    v_xor_b32 v30, 848, v31
    v_add_u32 v30, s67, v30
    v_lshrrev_b32 v8, 2, v2
    v_lshlrev_b32 v8, 8, v8
    v_lshl_add_u32 v8, v3, 6, v8
    v_lshl_add_u32 v8, v11, 3, v8
    v_add_u32 v254, 148224, v8
    v_and_b32 v9, 4, v2
    v_and_b32 v10, 8, v2
    v_lshlrev_b32 v9, 3, v9
    v_lshl_or_b32 v9, v10, 4, v9
    v_xor_b32 v9, v9, v8
    v_add_u32 v29, s66, v9
    v_xor_b32 v31, 32, v29
    s_mul_i32 s66, s3, 520
    v_lshl_add_u32 v8, v3, 5, v2
    v_lshl_add_u32 v230, v8, 2, s66
    v_mul_u32_u24 v14, 2080, v11
    v_lshl_add_u32 v231, v12, 2, v14
    v_add_u32 v231, 24576, v231
    v_lshlrev_b32 v14, 1, v11
    v_xor_b32 v14, v12, v14
    v_mul_u32_u24 v236, 2304, v11
    v_lshl_add_u32 v236, v14, 4, v236
    v_mov_b32 v26, 0x00003f80
    v_mov_b32 v27, 0x3f800000
    v_mov_b32 v28, 0xffff
    v_mov_b32 v247, 0
    v_mov_b32 v241, 0
    s_waitcnt vmcnt(2)
    s_barrier
    ds_read_b128 v[64:67], v253 offset:0
    ds_read_b128 v[68:71], v253 offset:1024
    ds_read_b128 v[72:75], v253 offset:2048
    ds_read_b128 v[80:83], v253 offset:3072
    ds_read_b128 v[84:87], v253 offset:4096
    s_setprio 3
    s_waitcnt lgkmcnt(0)
    v_pk_mul_f16 v72, v72, s42
    v_pk_mul_f16 v73, v73, s42
    v_pk_mul_f16 v74, v74, s42
    v_pk_mul_f16 v75, v75, s42
    v_pk_mul_f16 v76, v76, s42
    v_pk_mul_f16 v77, v77, s42
    s_lshl_b32 s68, s3, 10
    s_add_u32 s68, s68, 8192
    s_cmp_eq_u32 s2, 128
    s_cselect_b32 s69, 4, s3
    s_waitcnt vmcnt(0)
    ds_read_b64_tr_b16 v[152:153], v29
    ds_read_b64_tr_b16 v[154:155], v31
    v_mov_b32_dpp v12, v148 wave_rol:1 row_mask:0xf bank_mask:0xf
    v_bfi_b32 v13, v28, v151, v150
    v_bfi_b32 v14, v28, v150, v149
    v_bfi_b32 v15, v28, v149, v148
    v_bfi_b32 v12, v28, v12, v151
    ds_write_b128 v30, v[12:15]
    ds_read_b64_tr_b16 v[156:157], v29 offset:1024
    ds_read_b64_tr_b16 v[158:159], v31 offset:1024
    v_readfirstlane_b32 s45, v148
    s_waitcnt lgkmcnt(4)
    v_readfirstlane_b32 s44, v152
    s_nop 1
    v_dot2_f32_bf16 v32, v152, v26, s44 neg_lo:[0,0,1]
    v_dot2_f32_bf16 v34, v152, v27, s44 neg_lo:[0,0,1]
    v_dot2_f32_bf16 v40, v153, v26, s44 neg_lo:[0,0,1]
    v_dot2_f32_bf16 v42, v153, v27, s44 neg_lo:[0,0,1]
    s_waitcnt lgkmcnt(3)
    v_dot2_f32_bf16 v36, v154, v26, s44 neg_lo:[0,0,1]
    v_dot2_f32_bf16 v38, v154, v27, s44 neg_lo:[0,0,1]
    v_dot2_f32_bf16 v44, v155, v26, s44 neg_lo:[0,0,1]
    v_dot2_f32_bf16 v46, v155, v27, s44 neg_lo:[0,0,1]
    s_waitcnt lgkmcnt(1)
    v_dot2_f32_bf16 v33, v156, v26, s45 neg_lo:[0,0,1]
    v_dot2_f32_bf16 v35, v156, v27, s45 neg_lo:[0,0,1]
    v_dot2_f32_bf16 v41, v157, v26, s45 neg_lo:[0,0,1]
    v_dot2_f32_bf16 v43, v157, v27, s45 neg_lo:[0,0,1]
    s_waitcnt lgkmcnt(0)
    v_dot2_f32_bf16 v37, v158, v26, s45 neg_lo:[0,0,1]
    v_dot2_f32_bf16 v39, v158, v27, s45 neg_lo:[0,0,1]
    v_dot2_f32_bf16 v45, v159, v26, s45 neg_lo:[0,0,1]
    v_dot2_f32_bf16 v47, v159, v27, s45 neg_lo:[0,0,1]
    s_add_u32 m0, m0, 2048
    v_add_u32 v8, s68, v5
    buffer_load_dwordx4 v5, s[36:39], 0 offen lds
    s_add_u32 m0, s68, 65536
    s_cmp_lt_u32 s69, 4
    global_load_lds_dwordx4 v8, s[56:57]
    s_cbranch_scc0 L_nw_9
    buffer_store_dwordx4 v[140:143], v235, s[24:27], 0 offen sc1
    buffer_store_dwordx4 v[140:143], v235, s[24:27], s82 offen sc1
L_nw_9:
    v_pk_mul_f32 v[10:11], v[32:33], v[32:33]
    v_pk_add_f32 v[8:9], v[32:33], v[34:35]
    v_pk_fma_f32 v[10:11], v[34:35], v[34:35], v[10:11]
    v_pk_add_f32 v[8:9], v[8:9], v[36:37]
    v_pk_fma_f32 v[10:11], v[36:37], v[36:37], v[10:11]
    v_pk_add_f32 v[8:9], v[8:9], v[38:39]
    v_pk_fma_f32 v[10:11], v[38:39], v[38:39], v[10:11]
    v_pk_add_f32 v[8:9], v[8:9], v[40:41]
    v_pk_fma_f32 v[10:11], v[40:41], v[40:41], v[10:11]
    v_pk_add_f32 v[8:9], v[8:9], v[42:43]
    v_pk_fma_f32 v[10:11], v[42:43], v[42:43], v[10:11]
    v_pk_add_f32 v[8:9], v[8:9], v[44:45]
    v_pk_fma_f32 v[10:11], v[44:45], v[44:45], v[10:11]
    v_pk_add_f32 v[8:9], v[8:9], v[46:47]
    v_pk_fma_f32 v[10:11], v[46:47], v[46:47], v[10:11]
    s_setprio 2
    v_permlane32_swap_b32 v8, v9
    v_permlane32_swap_b32 v10, v11
    v_add_f32 v8, v8, v9
    v_add_f32 v10, v10, v11
    s_nop 1
    v_permlane16_swap_b32 v8, v10
    v_add_f32 v10, v8, v10
    s_nop 1
    v_add_f32_dpp v10, v10, v10 row_ror:8 row_mask:0xf bank_mask:0xf
    s_nop 1
    v_add_f32_dpp v10, v10, v10 row_ror:4 row_mask:0xf bank_mask:0xf
    s_nop 1
    v_add_f32_dpp v10, v10, v10 row_ror:2 row_mask:0xf bank_mask:0xf
    s_nop 1
    v_add_f32_dpp v10, v10, v10 row_ror:1 row_mask:0xf bank_mask:0xf
    v_mul_f32 v10, 0x3b000000, v10
    s_nop 1
    v_mov_b32_dpp v8, v10 row_bcast:15 row_mask:0xa bank_mask:0xf
    v_fma_f32 v10, -v8, v8, v10
    v_readlane_b32 s48, v8, 16
    v_max_f32 v10, 0, v10
    v_readlane_b32 s49, v8, 48
    v_add_f32 v11, 0x3727c5ac, v10
    v_rsq_f32 v9, v11
    v_mov_b32 v18, s48
    v_mov_b32 v19, s49
    v_readlane_b32 s46, v9, 16
    v_readlane_b32 s47, v9, 48
    s_nop 1
    v_pk_mul_f32 v[18:19], v[18:19], s[46:47]
    v_pk_fma_f32 v[160:161], v[32:33], s[46:47], v[18:19] neg_lo:[0,0,1] neg_hi:[0,0,1]
    v_pk_fma_f32 v[162:163], v[34:35], s[46:47], v[18:19] neg_lo:[0,0,1] neg_hi:[0,0,1]
    v_pk_fma_f32 v[164:165], v[36:37], s[46:47], v[18:19] neg_lo:[0,0,1] neg_hi:[0,0,1]
    v_pk_fma_f32 v[166:167], v[38:39], s[46:47], v[18:19] neg_lo:[0,0,1] neg_hi:[0,0,1]
    v_pk_fma_f32 v[168:169], v[40:41], s[46:47], v[18:19] neg_lo:[0,0,1] neg_hi:[0,0,1]
    v_pk_fma_f32 v[170:171], v[42:43], s[46:47], v[18:19] neg_lo:[0,0,1] neg_hi:[0,0,1]
    v_pk_fma_f32 v[172:173], v[44:45], s[46:47], v[18:19] neg_lo:[0,0,1] neg_hi:[0,0,1]
    v_pk_fma_f32 v[174:175], v[46:47], s[46:47], v[18:19] neg_lo:[0,0,1] neg_hi:[0,0,1]
    v_add_f32 v160, v160, v161
    v_add_f32 v162, v162, v163
    v_cvt_pk_f16_f32 v152, v160, v162
    v_add_f32 v164, v164, v165
    v_add_f32 v166, v166, v167
    v_cvt_pk_f16_f32 v153, v164, v166
    v_add_f32 v168, v168, v169
    v_add_f32 v170, v170, v171
    v_cvt_pk_f16_f32 v154, v168, v170
    v_add_f32 v172, v172, v173
    v_add_f32 v174, v174, v175
    v_cvt_pk_f16_f32 v155, v172, v174
    s_setprio 1
    v_mov_b32 v156, v152
    v_xor_b32 v157, 0x80008000, v153
    v_mfma_f32_16x16x32_f16 v[176:179], v[152:155], v[64:67], 0
    v_mov_b32 v158, v154
    v_xor_b32 v159, 0x80008000, v155
    v_mfma_f32_16x16x32_f16 v[180:183], v[152:155], v[68:71], 0
    s_nop 0
    v_mfma_f32_16x16x32_f16 v[184:187], v[156:159], v[64:67], 0
    v_mfma_f32_16x16x32_f16 v[188:191], v[156:159], v[68:71], 0
    s_nop 1
    v_cvt_pk_f16_f32 v20, v176, v177
    v_cvt_pk_f16_f32 v21, v178, v179
    s_nop 0
    v_cvt_pk_f16_f32 v22, v180, v181
    v_cvt_pk_f16_f32 v23, v182, v183
    v_pk_mul_f16 v144, v20, v80
    v_pk_mul_f16 v146, v22, v80
    v_pk_mul_f16 v145, v21, v81
    v_pk_mul_f16 v147, v23, v81
    v_pk_fma_f16 v144, v22, v82, v144
    v_pk_fma_f16 v146, v20, v82, v146 neg_lo:[1,0,0] neg_hi:[1,0,0]
    v_pk_fma_f16 v145, v23, v83, v145
    v_pk_fma_f16 v147, v21, v83, v147 neg_lo:[1,0,0] neg_hi:[1,0,0]
    s_nop 1
    v_mfma_f32_16x16x32_f16 v[160:163], v[72:75], v[144:147], 0
    v_mfma_f32_16x16x32_f16 v[168:171], v[76:79], v[144:147], 0
    s_setprio 0
    v_cvt_pk_f16_f32 v20, v184, v185
    v_cvt_pk_f16_f32 v21, v186, v187
    v_cvt_pk_f16_f32 v22, v188, v189
    v_cvt_pk_f16_f32 v23, v190, v191
    v_pk_mul_f16 v148, v20, v84
    v_pk_mul_f16 v150, v22, v84
    v_pk_mul_f16 v149, v21, v85
    v_pk_mul_f16 v151, v23, v85
    v_pk_fma_f16 v148, v22, v86, v148
    v_pk_fma_f16 v150, v20, v86, v150 neg_lo:[1,0,0] neg_hi:[1,0,0]
    v_pk_fma_f16 v149, v23, v87, v149
    v_pk_fma_f16 v151, v21, v87, v151 neg_lo:[1,0,0] neg_hi:[1,0,0]
    s_nop 1
    v_mfma_f32_16x16x32_f16 v[164:167], v[72:75], v[148:151], 0
    v_cndmask_b32_e64 v160, v160, v168, s[58:59]
    v_cvt_pk_f16_f32 v20, v160, v161
    v_cvt_pk_f16_f32 v21, v162, v163
    ds_write_b32 v230, v20 offset:24576
    ds_write_b32 v230, v21 offset:28736
    s_nop 2
    v_cvt_pk_f16_f32 v22, v164, v165
    v_cvt_pk_f16_f32 v23, v166, v167
    ds_write_b32 v230, v22 offset:24640
    ds_write_b32 v230, v23 offset:28800
    v_add_u32 v28, 1040, v231
    s_cmp_ge_u32 s3, 4
    s_cbranch_scc1 L_sAh_10
    s_waitcnt lgkmcnt(0)
    s_barrier
    ds_read2_b32 v[20:21], v231 offset0:0 offset1:130
    ds_read2_b32 v[22:23], v28 offset0:0 offset1:130
    ds_read2_b32 v[24:25], v231 offset0:64 offset1:194
    ds_read2_b32 v[26:27], v28 offset0:64 offset1:194
    s_waitcnt lgkmcnt(2)
    v_and_or_b32 v20, v20, v249, s60
    v_and_or_b32 v21, v21, v249, s61
    v_and_or_b32 v22, v22, v249, s62
    v_and_or_b32 v23, v23, v249, s63
    buffer_store_dwordx4 v[20:23], v234, s[24:27], 0 offen sc1
    s_waitcnt lgkmcnt(0)
    v_and_or_b32 v24, v24, v249, s60
    v_and_or_b32 v25, v25, v249, s61
    v_and_or_b32 v26, v26, v249, s62
    v_and_or_b32 v27, v27, v249, s63
    buffer_store_dwordx4 v[24:27], v234, s[24:27], s81 offen sc1
    s_branch L_sAj_11
L_sAh_10:
    s_waitcnt lgkmcnt(0)
    s_barrier
L_sAj_11:
    s_mul_i32 s66, s2, 1152
    s_lshl_b32 s67, s2, 10
    s_lshl_b32 s68, s2, 7
    s_cmp_eq_u32 s3, 0
    s_cbranch_scc0 L_only_12
    s_add_u32 s75, s66, 2159360
    buffer_store_dwordx4 v[140:143], v5, s[24:27], s75 offen sc1
    s_mov_b64 exec, 0xff
    buffer_store_dwordx4 v[140:143], v5, s[24:27], s75 offen offset:1024 sc1
    s_mov_b64 exec, -1
L_only_12:
    s_cmp_eq_u32 s3, 1
    s_cbranch_scc0 L_only_13
    s_add_u32 s75, s66, 2307968
    buffer_store_dwordx4 v[140:143], v5, s[24:27], s75 offen sc1
    s_mov_b64 exec, 0xff
    buffer_store_dwordx4 v[140:143], v5, s[24:27], s75 offen offset:1024 sc1
    s_mov_b64 exec, -1
L_only_13:
    s_cmp_eq_u32 s3, 2
    s_cbranch_scc0 L_only_14
    s_cmp_lt_u32 s2, 28
    s_cbranch_scc0 L_only_15
    s_add_u32 s75, s67, 2456576
    buffer_store_dwordx4 v[140:143], v5, s[24:27], s75 offen sc1
    s_add_u32 s75, s68, 2139136
    s_mov_b64 exec, 0xff
    buffer_store_dwordx4 v[140:143], v5, s[24:27], s75 offen sc1
    s_mov_b64 exec, -1
L_only_15:
    s_mul_i32 s75, s2, 32
    s_add_u32 s75, s75, 2097152
    s_mov_b64 exec, 1
    buffer_store_dwordx2 v[140:141], v5, s[24:27], s75 offen sc1
    s_mov_b64 exec, -1
L_only_14:
    s_cmp_eq_u32 s3, 3
    s_cbranch_scc0 L_only_16
    s_cmp_lt_u32 s2, 28
    s_cbranch_scc0 L_only_17
    s_add_u32 s75, s67, 2485248
    buffer_store_dwordx4 v[140:143], v5, s[24:27], s75 offen sc1
    s_add_u32 s75, s68, 2135552
    s_mov_b64 exec, 0xff
    buffer_store_dwordx4 v[140:143], v5, s[24:27], s75 offen sc1
    s_mov_b64 exec, -1
L_only_17:
    s_mul_i32 s75, s2, 32
    s_add_u32 s75, s75, 2114560
    s_mov_b64 exec, 1
    buffer_store_dwordx2 v[140:141], v5, s[24:27], s75 offen sc1
    s_mov_b64 exec, -1
L_only_16:
    s_cmp_lt_u32 s3, 4
    s_cbranch_scc0 L_only_18
    ds_read_b128 v[120:123], v253 offset:5120
    ds_read_b128 v[124:127], v253 offset:6144
    v_bfe_u32 v12, v0, 2, 6
    v_sub_u32 v14, 256, v12
    v_and_b32 v14, 255, v14
    s_mov_b32 s50, 0xcccccccc
    s_mov_b32 s51, 0xcccccccc
    v_and_b32 v15, 1, v0
    v_cndmask_b32_e64 v14, v12, v14, s[50:51]
    v_mul_u32_u24 v255, 4224, v15
    v_lshl_add_u32 v242, v14, 4, v255
    v_add_u32 v14, 64, v12
    v_sub_u32 v16, 192, v12
    v_cndmask_b32_e64 v14, v14, v16, s[50:51]
    v_lshl_add_u32 v255, v14, 4, v255
    v_and_b32 v14, 1, v3
    v_lshrrev_b32 v15, 1, v3
    v_lshlrev_b32 v16, 1, v14
    v_xor_b32 v17, v2, v16
    v_lshl_add_u32 v17, v15, 5, v17
    v_mul_u32_u24 v18, 2304, v14
    v_lshl_add_u32 v237, v17, 4, v18
    v_xor_b32 v238, 64, v237
    v_add_u32 v238, 4608, v238
    v_mov_b32 v239, 2240
    v_mov_b32 v240, 2240
    v_mov_b32 v246, 149312
    ds_write_b64 v239, v[78:79] offset:41472
    ds_write_b64 v239, v[78:79] offset:41480
    ds_write_b64 v246, v[78:79]
    ds_write_b64 v246, v[78:79] offset:8
    ds_write_b64 v246, v[78:79] offset:16
    ds_write_b64 v246, v[78:79] offset:24
    s_mov_b64 exec, 0x10001
    v_add_u32 v239, 2048, v237
    v_add_u32 v240, 2048, v238
    s_mov_b64 exec, -1
    s_lshl_b32 s66, s3, 4
    v_add_u32 v27, s66, v2
    v_cvt_f32_u32 v27, v27
    v_lshl_add_u32 v24, v14, 5, v15
    v_cvt_f32_u32 v24, v24
    v_cvt_f32_u32 v25, v3
    v_mul_f32 v29, v24, v27
    v_mul_f32 v29, 0x3c800000, v29
    v_mov_b32 v8, v29
    v_fmamk_f32 v9, v27, 0x3e000000, v29
    v_fmamk_f32 v10, v27, 0x3e800000, v29
    v_fmamk_f32 v11, v27, 0x3ec00000, v29
    v_cos_f32 v12, v8
    v_sin_f32 v16, v8
    v_cos_f32 v13, v9
    v_sin_f32 v17, v9
    v_cos_f32 v14, v10
    v_sin_f32 v18, v10
    v_cos_f32 v15, v11
    v_sin_f32 v19, v11
    v_cvt_pk_f16_f32 v88, v12, v16
    v_cvt_pk_f16_f32 v92, -v16, v12
    v_cvt_pk_f16_f32 v89, v13, v17
    v_cvt_pk_f16_f32 v93, -v17, v13
    v_cvt_pk_f16_f32 v90, v14, v18
    v_cvt_pk_f16_f32 v94, -v18, v14
    v_cvt_pk_f16_f32 v91, v15, v19
    v_cvt_pk_f16_f32 v95, -v19, v15
    v_fmamk_f32 v8, v27, 0x3d000000, v29
    v_fmamk_f32 v9, v27, 0x3e200000, v29
    v_fmamk_f32 v10, v27, 0x3e900000, v29
    v_fmamk_f32 v11, v27, 0x3ed00000, v29
    v_cos_f32 v12, v8
    v_sin_f32 v16, v8
    v_cos_f32 v13, v9
    v_sin_f32 v17, v9
    v_cos_f32 v14, v10
    v_sin_f32 v18, v10
    v_cos_f32 v15, v11
    v_sin_f32 v19, v11
    v_cvt_pk_f16_f32 v96, v12, v16
    v_cvt_pk_f16_f32 v100, -v16, v12
    v_cvt_pk_f16_f32 v97, v13, v17
    v_cvt_pk_f16_f32 v101, -v17, v13
    v_cvt_pk_f16_f32 v98, v14, v18
    v_cvt_pk_f16_f32 v102, -v18, v14
    v_cvt_pk_f16_f32 v99, v15, v19
    v_cvt_pk_f16_f32 v103, -v19, v15
    v_fmamk_f32 v8, v27, 0x3d800000, v29
    v_fmamk_f32 v9, v27, 0x3e400000, v29
    v_fmamk_f32 v10, v27, 0x3ea00000, v29
    v_fmamk_f32 v11, v27, 0x3ee00000, v29
    v_cos_f32 v12, v8
    v_sin_f32 v16, v8
    v_cos_f32 v13, v9
    v_sin_f32 v17, v9
    v_cos_f32 v14, v10
    v_sin_f32 v18, v10
    v_cos_f32 v15, v11
    v_sin_f32 v19, v11
    v_cvt_pk_f16_f32 v104, v12, v16
    v_cvt_pk_f16_f32 v108, -v16, v12
    v_cvt_pk_f16_f32 v105, v13, v17
    v_cvt_pk_f16_f32 v109, -v17, v13
    v_cvt_pk_f16_f32 v106, v14, v18
    v_cvt_pk_f16_f32 v110, -v18, v14
    v_cvt_pk_f16_f32 v107, v15, v19
    v_cvt_pk_f16_f32 v111, -v19, v15
    v_mul_f32 v29, v27, v25
    v_mul_f32 v29, 0x3b000000, v29
    v_mov_b32 v8, v29
    v_fmamk_f32 v9, v27, 0x3a000000, v29
    v_fmamk_f32 v10, v27, 0x3a800000, v29
    v_fmamk_f32 v11, v27, 0x3ac00000, v29
    v_cos_f32 v12, v8
    v_sin_f32 v16, v8
    v_cos_f32 v13, v9
    v_sin_f32 v17, v9
    v_cos_f32 v14, v10
    v_sin_f32 v18, v10
    v_cos_f32 v15, v11
    v_sin_f32 v19, v11
    v_cvt_pk_f16_f32 v112, v12, v13
    v_cvt_pk_f16_f32 v113, v14, v15
    v_cvt_pk_f16_f32 v114, v16, v17
    v_cvt_pk_f16_f32 v115, v18, v19
    v_fmamk_f32 v8, v27, 0x3c000000, v29
    v_fmamk_f32 v9, v27, 0x3c080000, v29
    v_fmamk_f32 v10, v27, 0x3c100000, v29
    v_fmamk_f32 v11, v27, 0x3c180000, v29
    v_cos_f32 v12, v8
    v_sin_f32 v16, v8
    v_cos_f32 v13, v9
    v_sin_f32 v17, v9
    v_cos_f32 v14, v10
    v_sin_f32 v18, v10
    v_cos_f32 v15, v11
    v_sin_f32 v19, v11
    v_cvt_pk_f16_f32 v116, v12, v13
    v_cvt_pk_f16_f32 v117, v14, v15
    v_cvt_pk_f16_f32 v118, v16, v17
    v_cvt_pk_f16_f32 v119, v18, v19
    s_waitcnt lgkmcnt(0)
    v_xor_b32 v128, 0x80000000, v120
    v_xor_b32 v129, 0x80000000, v121
    v_xor_b32 v130, 0x80000000, v122
    v_xor_b32 v131, 0x80000000, v123
    v_xor_b32 v132, 0x80000000, v124
    v_xor_b32 v133, 0x80000000, v125
    v_xor_b32 v134, 0x80000000, v126
    v_xor_b32 v135, 0x80000000, v127
    s_lshl_b32 s67, s3, 8
    v_lshlrev_b32 v241, 10, v3
    v_lshl_add_u32 v241, v2, 4, v241
    v_add_u32 v241, s67, v241
L_only_18:
    s_cmp_ge_u32 s3, 4
    s_cbranch_scc1 L_cH_19
    s_cmp_eq_u32 s2, 128
    s_cbranch_scc1 L_c128_20
    s_setprio 2
    s_waitcnt lgkmcnt(0)
    s_barrier
    ds_read_b128 v[152:155], v237 offset:41728
    ds_read_b128 v[156:159], v237 offset:42752
    ds_read_b128 v[144:147], v237 offset:41472
    ds_read_b128 v[148:151], v237 offset:42496
    ds_read_b128 v[160:163], v239 offset:41472
    ds_read_b128 v[172:175], v238 offset:41728
    ds_read_b128 v[176:179], v238 offset:42752
    ds_read_b128 v[164:167], v238 offset:41472
    ds_read_b128 v[168:171], v238 offset:42496
    ds_read_b128 v[180:183], v240 offset:41472
    s_waitcnt lgkmcnt(9)
    v_mfma_f32_16x16x32_f16 v[192:195], v[152:155], v[88:91], 0
    v_mfma_f32_16x16x32_f16 v[196:199], v[152:155], v[92:95], 0
    s_waitcnt lgkmcnt(8)
    v_mfma_f32_16x16x32_f16 v[192:195], v[156:159], v[96:99], v[192:195]
    v_mfma_f32_16x16x32_f16 v[196:199], v[156:159], v[100:103], v[196:199]
    s_waitcnt lgkmcnt(7)
    v_mfma_f32_16x16x32_f16 v[184:187], v[144:147], v[88:91], 0
    s_nop 1
    v_mfma_f32_16x16x32_f16 v[188:191], v[144:147], v[92:95], 0
    s_waitcnt lgkmcnt(3)
    v_mfma_f32_16x16x32_f16 v[184:187], v[148:151], v[96:99], v[184:187]
    v_cvt_pk_f16_f32 v24, v192, v193
    v_cvt_pk_f16_f32 v25, v194, v195
    v_mfma_f32_16x16x32_f16 v[188:191], v[148:151], v[100:103], v[188:191]
    v_cvt_pk_f16_f32 v26, v196, v197
    v_cvt_pk_f16_f32 v27, v198, v199
    v_mfma_f32_16x16x32_f16 v[184:187], v[160:163], v[104:107], v[184:187]
    v_pk_mul_f16 v152, v24, v116
    v_pk_mul_f16 v154, v26, v116
    v_mfma_f32_16x16x32_f16 v[188:191], v[160:163], v[108:111], v[188:191]
    v_pk_mul_f16 v153, v25, v117
    v_pk_mul_f16 v155, v27, v117
    v_mfma_f32_16x16x32_f16 v[208:211], v[172:175], v[88:91], 0
    v_pk_fma_f16 v152, v26, v118, v152
    v_pk_fma_f16 v154, v24, v118, v154 neg_lo:[1,0,0] neg_hi:[1,0,0]
    v_mfma_f32_16x16x32_f16 v[212:215], v[172:175], v[92:95], 0
    v_pk_fma_f16 v153, v27, v119, v153
    v_pk_fma_f16 v155, v25, v119, v155 neg_lo:[1,0,0] neg_hi:[1,0,0]
    v_mfma_f32_16x16x32_f16 v[208:211], v[176:179], v[96:99], v[208:211]
    v_cvt_pk_f16_f32 v20, v184, v185
    v_cvt_pk_f16_f32 v21, v186, v187
    v_mfma_f32_16x16x32_f16 v[212:215], v[176:179], v[100:103], v[212:215]
    v_cvt_pk_f16_f32 v22, v188, v189
    v_cvt_pk_f16_f32 v23, v190, v191
    s_waitcnt lgkmcnt(0)
    v_mfma_f32_16x16x32_f16 v[200:203], v[164:167], v[88:91], 0
    v_pk_mul_f16 v156, v20, v112
    v_pk_mul_f16 v158, v22, v112
    v_mfma_f32_16x16x32_f16 v[204:207], v[164:167], v[92:95], 0
    v_pk_mul_f16 v157, v21, v113
    v_pk_mul_f16 v159, v23, v113
    v_mfma_f32_16x16x32_f16 v[200:203], v[168:171], v[96:99], v[200:203]
    v_pk_fma_f16 v156, v22, v114, v156
    v_pk_fma_f16 v158, v20, v114, v158 neg_lo:[1,0,0] neg_hi:[1,0,0]
    v_mfma_f32_16x16x32_f16 v[204:207], v[168:171], v[100:103], v[204:207]
    v_pk_fma_f16 v157, v23, v115, v157
    v_pk_fma_f16 v159, v21, v115, v159 neg_lo:[1,0,0] neg_hi:[1,0,0]
    v_mfma_f32_16x16x32_f16 v[200:203], v[180:183], v[104:107], v[200:203]
    v_cvt_pk_f16_f32 v24, v208, v209
    v_cvt_pk_f16_f32 v25, v210, v211
    v_mfma_f32_16x16x32_f16 v[204:207], v[180:183], v[108:111], v[204:207]
    v_cvt_pk_f16_f32 v26, v212, v213
    v_cvt_pk_f16_f32 v27, v214, v215
    v_mfma_f32_16x16x32_f16 v[216:219], v[124:127], v[152:155], 0
    v_pk_mul_f16 v144, v24, v116
    v_pk_mul_f16 v146, v26, v116
    v_mfma_f32_16x16x32_f16 v[220:223], v[132:135], v[152:155], 0
    v_pk_mul_f16 v145, v25, v117
    v_pk_mul_f16 v147, v27, v117
    v_mfma_f32_16x16x32_f16 v[216:219], v[120:123], v[156:159], v[216:219]
    v_pk_fma_f16 v144, v26, v118, v144
    v_pk_fma_f16 v146, v24, v118, v146 neg_lo:[1,0,0] neg_hi:[1,0,0]
    v_mfma_f32_16x16x32_f16 v[220:223], v[128:131], v[156:159], v[220:223]
    v_pk_fma_f16 v145, v27, v119, v145
    v_pk_fma_f16 v147, v25, v119, v147 neg_lo:[1,0,0] neg_hi:[1,0,0]
    v_cvt_pk_f16_f32 v20, v200, v201
    v_cvt_pk_f16_f32 v21, v202, v203
    v_mfma_f32_16x16x32_f16 v[184:187], v[124:127], v[144:147], 0
    v_cvt_pk_f16_f32 v22, v204, v205
    v_cvt_pk_f16_f32 v23, v206, v207
    v_pk_mul_f16 v148, v20, v112
    v_pk_mul_f16 v150, v22, v112
    v_pk_mul_f16 v149, v21, v113
    v_mfma_f32_16x16x32_f16 v[188:191], v[132:135], v[144:147], 0
    v_pk_mul_f16 v151, v23, v113
    v_pk_fma_f16 v148, v22, v114, v148
    v_pk_fma_f16 v150, v20, v114, v150 neg_lo:[1,0,0] neg_hi:[1,0,0]
    v_pk_fma_f16 v149, v23, v115, v149
    v_pk_fma_f16 v151, v21, v115, v151 neg_lo:[1,0,0] neg_hi:[1,0,0]
    s_nop 1
    v_mfma_f32_16x16x32_f16 v[184:187], v[120:123], v[148:151], v[184:187]
    v_mfma_f32_16x16x32_f16 v[188:191], v[128:131], v[148:151], v[188:191]
    s_nop 6
    v_cvt_pk_f16_f32 v8, v216, v184
    v_cvt_pk_f16_f32 v9, v217, v185
    v_cvt_pk_f16_f32 v10, v218, v186
    v_cvt_pk_f16_f32 v11, v219, v187
    ds_write_b128 v241, v[8:11] offset:50688
    v_cvt_pk_f16_f32 v12, v220, v188
    v_cvt_pk_f16_f32 v13, v221, v189
    v_cvt_pk_f16_f32 v14, v222, v190
    v_cvt_pk_f16_f32 v15, v223, v191
    ds_write_b128 v241, v[12:15] offset:54912
    s_waitcnt vmcnt(0) lgkmcnt(0)
    s_barrier
    ds_read_b128 v[12:15], v242 offset:50688
    ds_read_b128 v[16:19], v255 offset:50688
    ds_read_b128 v[20:23], v242 offset:52736
    s_waitcnt lgkmcnt(2)
    v_and_or_b32 v12, v12, v249, s60
    v_and_or_b32 v13, v13, v249, s61
    v_and_or_b32 v14, v14, v249, s62
    v_and_or_b32 v15, v15, v249, s63
    buffer_store_dwordx4 v[12:15], v235, s[24:27], 0 offen sc1
    s_waitcnt lgkmcnt(1)
    v_and_or_b32 v16, v16, v249, s60
    v_and_or_b32 v17, v17, v249, s61
    v_and_or_b32 v18, v18, v249, s62
    v_and_or_b32 v19, v19, v249, s63
    buffer_store_dwordx4 v[16:19], v235, s[24:27], s82 offen sc1
    s_waitcnt lgkmcnt(0)
    s_cmp_eq_u32 s3, 0
    s_cbranch_scc0 L_only_24
    s_mov_b64 exec, 0xf
    s_mov_b32 s76, 1048576
    v_and_or_b32 v20, v20, v249, s60
    v_and_or_b32 v21, v21, v249, s61
    v_and_or_b32 v22, v22, v249, s62
    v_and_or_b32 v23, v23, v249, s63
    buffer_store_dwordx4 v[20:23], v235, s[24:27], s76 offen sc1
    s_mov_b64 exec, -1
L_only_24:
    s_branch L_cjoin_23
L_c128_20:
    s_waitcnt lgkmcnt(0)
    s_barrier
    s_waitcnt vmcnt(0)
    s_barrier
    s_branch L_cjoin_23
L_cH_19:
    s_cmp_eq_u32 s2, 128
    s_cbranch_scc1 L_cHb_21
    s_setprio 3
    s_cmp_eq_u32 s3, 4
    s_cbranch_scc0 L_only_25
    v_and_b32 v8, 48, v5
    v_add_u32 v8, 8192, v8
    s_mov_b32 s70, 262144
    s_sleep 16
    s_branch L_poll_27
L_retry_26:
    s_sub_u32 s70, s70, 1
    s_cbranch_scc1 L_polld_29
    s_wqm_b64 exec, vcc
L_poll_27:
    buffer_load_dwordx4 v[12:15], v4, s[24:27], s77 offen sc1
    buffer_load_dwordx4 v[16:19], v4, s[24:27], s79 offen sc1
    buffer_load_dwordx4 v[20:23], v8, s[24:27], s77 offen sc1
L_pollc_28:
    s_waitcnt vmcnt(0)
    ds_write_b128 v236, v[12:15] offset:41472
    ds_write_b128 v236, v[16:19] offset:42496
    s_mov_b64 s[50:51], exec
    s_and_b64 exec, exec, 0xf
    ds_write_b128 v236, v[20:23] offset:43520
    s_mov_b64 exec, s[50:51]
    v_xor_b32 v31, s60, v12
    v_bitop3_b32 v31, v31, v13, s61 bitop3:0xf6
    v_bitop3_b32 v31, v31, v14, s62 bitop3:0xf6
    v_bitop3_b32 v31, v31, v15, s63 bitop3:0xf6
    v_bitop3_b32 v31, v31, v16, s60 bitop3:0xf6
    v_bitop3_b32 v31, v31, v17, s61 bitop3:0xf6
    v_bitop3_b32 v31, v31, v18, s62 bitop3:0xf6
    v_bitop3_b32 v31, v31, v19, s63 bitop3:0xf6
    v_bitop3_b32 v31, v31, v20, s60 bitop3:0xf6
    v_bitop3_b32 v31, v31, v21, s61 bitop3:0xf6
    v_bitop3_b32 v31, v31, v22, s62 bitop3:0xf6
    v_bitop3_b32 v31, v31, v23, s63 bitop3:0xf6
    v_and_b32 v31, 0x30003, v31
    v_cmp_ne_u32 vcc, 0, v31
    s_cbranch_vccnz L_retry_26
L_polld_29:
    s_mov_b64 exec, -1
    s_waitcnt lgkmcnt(0)
    s_barrier
    s_branch L_cHc_22
L_only_25:
    s_mov_b32 s70, 262144
    s_sleep 16
    s_branch L_poll_32
L_retry_31:
    s_sub_u32 s70, s70, 1
    s_cbranch_scc1 L_polld_34
    s_wqm_b64 exec, vcc
L_poll_32:
    buffer_load_dwordx4 v[12:15], v4, s[24:27], s77 offen sc1
    buffer_load_dwordx4 v[16:19], v4, s[24:27], s79 offen sc1
L_pollc_33:
    s_waitcnt vmcnt(0)
    ds_write_b128 v236, v[12:15] offset:41472
    ds_write_b128 v236, v[16:19] offset:42496
    v_xor_b32 v31, s60, v12
    v_bitop3_b32 v31, v31, v13, s61 bitop3:0xf6
    v_bitop3_b32 v31, v31, v14, s62 bitop3:0xf6
    v_bitop3_b32 v31, v31, v15, s63 bitop3:0xf6
    v_bitop3_b32 v31, v31, v16, s60 bitop3:0xf6
    v_bitop3_b32 v31, v31, v17, s61 bitop3:0xf6
    v_bitop3_b32 v31, v31, v18, s62 bitop3:0xf6
    v_bitop3_b32 v31, v31, v19, s63 bitop3:0xf6
    v_and_b32 v31, 0x30003, v31
    v_cmp_ne_u32 vcc, 0, v31
    s_cbranch_vccnz L_retry_31
L_polld_34:
    s_mov_b64 exec, -1
L_cHb_21:
    s_waitcnt lgkmcnt(0)
    s_barrier
L_cHc_22:
    s_setprio 0
    s_cmp_lg_u32 s2, 128
    s_cbranch_scc0 L_only_36
    buffer_store_dwordx4 v[140:143], v4, s[24:27], s77 offen sc1
    buffer_store_dwordx4 v[140:143], v4, s[24:27], s79 offen sc1
    s_cmp_eq_u32 s3, 4
    s_cbranch_scc0 L_only_37
    s_add_u32 s64, s77, 8192
    s_mov_b64 exec, 0xf
    buffer_store_dwordx4 v[140:143], v5, s[24:27], s64 offen sc1
    s_mov_b64 exec, -1
L_only_37:
L_only_36:
    s_waitcnt vmcnt(0)
    s_barrier
L_cjoin_23:
    s_setprio 0
    s_mul_i32 s66, s3, 3072
    v_lshlrev_b32 v8, 6, v3
    v_lshl_add_u32 v8, v2, 1, v8
    v_add_u32 v226, s66, v8
    v_sub_u32 v9, 1024, v8
    v_and_b32 v10, 1023, v9
    v_add_u32 v228, s66, v10
    s_sub_u32 s67, s66, 800
    v_add_u32 v227, s67, v9
    ds_read_u16_d16_hi v48, v226 offset:2048
    ds_read_u16_d16_hi v49, v228 offset:2048
    ds_read_u16_d16_hi v50, v226 offset:2304
    ds_read_u16_d16_hi v51, v227 offset:2592
    ds_read_u16_d16_hi v52, v226 offset:2080
    ds_read_u16_d16_hi v53, v227 offset:2816
    ds_read_u16_d16_hi v54, v226 offset:2336
    ds_read_u16_d16_hi v55, v227 offset:2560
    ds_read_u16_d16_hi v56, v226 offset:2560
    ds_read_u16_d16_hi v57, v227 offset:2336
    ds_read_u16_d16_hi v58, v226 offset:2816
    ds_read_u16_d16_hi v59, v227 offset:2080
    ds_read_u16_d16_hi v60, v226 offset:2592
    ds_read_u16_d16_hi v61, v227 offset:2304
    ds_read_u16_d16_hi v62, v226 offset:2848
    ds_read_u16_d16_hi v63, v227 offset:2048
    s_sub_u32 s66, 7, s3
    s_sub_u32 s67, 8, s3
    s_and_b32 s67, s67, 7
    s_cmp_eq_u32 s2, 0
    s_cselect_b32 s66, s67, s66
    s_mul_i32 s66, s66, 520
    s_add_u32 s66, s66, 37184
    v_lshlrev_b32 v9, 1, v8
    v_sub_u32 v9, 512, v9
    v_and_b32 v10, 511, v9
    v_add_u32 v232, s66, v10
    s_sub_u32 s66, s66, 64
    v_add_u32 v233, s66, v9
    v_mov_b32 v246, 149312
    v_mov_b32 v248, 1
    s_sub_u32 s66, 2047, s40
    s_sub_u32 s67, 2047, s41
    v_mov_b32 v243, s67
    v_mov_b32 v244, -1
    v_mov_b32 v245, 0
    s_mov_b32 exec_hi, 0
    v_mov_b32 v243, s66
    s_mov_b32 exec_lo, 1
    v_mov_b32 v244, 0xffff0000
    v_mov_b32 v245, 16
    s_mov_b64 exec, -1
    v_mov_b32 v224, s44
    v_mov_b32 v225, s45
    s_and_b32 s68, s3, 3
    s_lshl_b32 s67, s68, 8
    v_lshlrev_b32 v241, 10, v3
    v_lshl_add_u32 v241, v2, 4, v241
    v_add_u32 v241, s67, v241
    v_lshrrev_b32 v10, 3, v2
    v_and_b32 v11, 7, v2
    v_and_b32 v9, 1, v3
    v_lshl_add_u32 v11, v11, 1, v9
    s_lshl_b32 s66, s68, 5
    v_lshl_add_u32 v250, v10, 4, v11
    v_add_lshl_u32 v250, v250, s66, 1
    v_lshl_add_u32 v251, v11, 4, s67
    v_lshl_add_u32 v251, v10, 3, v251
    s_waitcnt lgkmcnt(0)
    v_add_f32 v8, v48, v50
    v_add_f32 v8, v8, v52
    v_add_f32 v8, v8, v54
    v_add_f32 v8, v8, v56
    v_add_f32 v8, v8, v58
    v_add_f32 v8, v8, v60
    v_add_f32 v8, v8, v62
    s_nop 1
    v_add_f32_dpp v8, v8, v8 row_ror:8 row_mask:0xf bank_mask:0xf
    s_nop 1
    v_add_f32_dpp v8, v8, v8 row_ror:4 row_mask:0xf bank_mask:0xf
    s_nop 1
    v_add_f32_dpp v8, v8, v8 row_ror:2 row_mask:0xf bank_mask:0xf
    s_nop 1
    v_add_f32_dpp v8, v8, v8 row_ror:1 row_mask:0xf bank_mask:0xf
    s_nop 1
    v_add_f32_dpp v8, v8, v8 row_bcast:15 row_mask:0xa bank_mask:0xf
    s_nop 1
    v_add_f32_dpp v8, v8, v8 row_bcast:31 row_mask:0xc bank_mask:0xf
    v_mul_f32 v8, 0x3b000000, v8
    s_nop 0
    v_readlane_b32 s64, v8, 63
    s_nop 1
    v_subrev_f32 v48, s64, v48
    v_subrev_f32 v49, s64, v49
    v_subrev_f32 v50, s64, v50
    v_subrev_f32 v51, s64, v51
    v_subrev_f32 v52, s64, v52
    v_subrev_f32 v53, s64, v53
    v_subrev_f32 v54, s64, v54
    v_subrev_f32 v55, s64, v55
    v_subrev_f32 v56, s64, v56
    v_subrev_f32 v57, s64, v57
    v_subrev_f32 v58, s64, v58
    v_subrev_f32 v59, s64, v59
    v_subrev_f32 v60, s64, v60
    v_subrev_f32 v61, s64, v61
    v_subrev_f32 v62, s64, v62
    v_subrev_f32 v63, s64, v63
    s_and_b32 s64, s2, 127
    s_cselect_b32 s45, 0x10000, 0
    s_cselect_b32 s41, s41, 4096
    s_mov_b32 s44, 0x10000
    s_mov_b32 s28, 0x80000000
    s_mov_b32 s29, 0xfffff800
    s_mul_i32 s36, s2, 32
    s_add_u32 s36, s36, 2097152
    s_mul_i32 s37, s2, 1152
    s_add_u32 s37, s37, 2159360
    s_setprio 3
    s_cmp_lt_u32 s3, 4
    s_cbranch_scc1 L_y1l_38
    v_add_u32 v28, 8448, v231
    v_add_u32 v29, 9488, v231
    s_mov_b32 s70, 262144
    s_sleep 4
    s_branch L_poll_41
L_retry_40:
    s_sub_u32 s70, s70, 1
    s_cbranch_scc1 L_polld_43
    s_wqm_b64 exec, vcc
L_poll_41:
    buffer_load_dwordx4 v[12:15], v4, s[24:27], s78 offen sc1
    buffer_load_dwordx4 v[16:19], v4, s[24:27], s80 offen sc1
L_pollc_42:
    s_waitcnt vmcnt(0)
    ds_write2_b32 v28, v12, v13 offset0:0 offset1:130
    ds_write2_b32 v29, v14, v15 offset0:0 offset1:130
    ds_write2_b32 v28, v16, v17 offset0:64 offset1:194
    ds_write2_b32 v29, v18, v19 offset0:64 offset1:194
    v_xor_b32 v31, s60, v12
    v_bitop3_b32 v31, v31, v13, s61 bitop3:0xf6
    v_bitop3_b32 v31, v31, v14, s62 bitop3:0xf6
    v_bitop3_b32 v31, v31, v15, s63 bitop3:0xf6
    v_bitop3_b32 v31, v31, v16, s60 bitop3:0xf6
    v_bitop3_b32 v31, v31, v17, s61 bitop3:0xf6
    v_bitop3_b32 v31, v31, v18, s62 bitop3:0xf6
    v_bitop3_b32 v31, v31, v19, s63 bitop3:0xf6
    v_and_b32 v31, 0x30003, v31
    v_cmp_ne_u32 vcc, 0, v31
    s_cbranch_vccnz L_retry_40
L_polld_43:
    s_mov_b64 exec, -1
    s_waitcnt lgkmcnt(0)
    s_barrier
    ds_read_b32 v17, v230 offset:33088
    ds_read_b32 v19, v233
    ds_read_b32 v16, v230 offset:33024
    ds_read_b32 v18, v232
    buffer_store_dwordx4 v[140:143], v4, s[24:27], s78 offen sc1
    buffer_store_dwordx4 v[140:143], v4, s[24:27], s80 offen sc1
    s_branch L_y1j_39
L_y1l_38:
    s_cmp_lt_u32 s2, 28
    s_cselect_b32 s30, s3, 0
    s_cmp_eq_u32 s30, 3
    s_cselect_b32 s30, 1, 0
    s_barrier
    ds_read_b32 v17, v230 offset:33088
    ds_read_b32 v19, v233
    ds_read_b32 v16, v230 offset:33024
    ds_read_b32 v18, v232
    s_cmp_eq_u32 s30, 1
    s_cbranch_scc0 L_only_45
    s_lshl_b32 s69, s2, 7
    s_add_u32 s69, s69, 2131968
    v_mov_b32 v28, 1
    v_mov_b32 v29, 0x5a17c3e8
    s_mov_b64 exec, 1
    buffer_store_dwordx2 v[28:29], v5, s[24:27], s69 offen sc1
    s_mov_b64 exec, -1
L_only_45:
L_y1j_39:
    s_waitcnt lgkmcnt(3)
    v_fma_mix_f32 v36, v17, s74, v36 op_sel:[0,0,0] op_sel_hi:[1,0,0]
    v_fma_mix_f32 v37, v17, s74, v37 op_sel:[0,0,0] op_sel_hi:[1,0,0]
    v_fma_mix_f32 v38, v17, s74, v38 op_sel:[1,0,0] op_sel_hi:[1,0,0]
    v_fma_mix_f32 v39, v17, s74, v39 op_sel:[1,0,0] op_sel_hi:[1,0,0]
    s_waitcnt lgkmcnt(2)
    v_fma_mix_f32 v44, v19, s74, v44 op_sel:[1,0,0] op_sel_hi:[1,0,0]
    v_fma_mix_f32 v45, v19, s74, v45 op_sel:[1,0,0] op_sel_hi:[1,0,0]
    v_fma_mix_f32 v46, v19, s74, v46 op_sel:[0,0,0] op_sel_hi:[1,0,0]
    v_fma_mix_f32 v47, v19, s74, v47 op_sel:[0,0,0] op_sel_hi:[1,0,0]
    s_waitcnt lgkmcnt(1)
    v_and_b32 v16, v244, v16
    v_fma_mix_f32 v32, v16, s74, v32 op_sel:[0,0,0] op_sel_hi:[1,0,0]
    v_fma_mix_f32 v33, v16, s74, v33 op_sel:[0,0,0] op_sel_hi:[1,0,0]
    v_fma_mix_f32 v34, v16, s74, v34 op_sel:[1,0,0] op_sel_hi:[1,0,0]
    v_fma_mix_f32 v35, v16, s74, v35 op_sel:[1,0,0] op_sel_hi:[1,0,0]
    s_waitcnt lgkmcnt(0)
    v_alignbit_b32 v18, v18, v18, v245
    v_fma_mix_f32 v40, v18, s74, v40 op_sel:[1,0,0] op_sel_hi:[1,0,0]
    v_fma_mix_f32 v41, v18, s74, v41 op_sel:[1,0,0] op_sel_hi:[1,0,0]
    v_fma_mix_f32 v42, v18, s74, v42 op_sel:[0,0,0] op_sel_hi:[1,0,0]
    v_fma_mix_f32 v43, v18, s74, v43 op_sel:[0,0,0] op_sel_hi:[1,0,0]
    s_setprio 2
    v_pk_mul_f32 v[10:11], v[36:37], v[36:37]
    v_pk_mul_f32 v[12:13], v[36:37], v[52:53]
    v_pk_add_f32 v[8:9], v[36:37], v[38:39]
    v_pk_fma_f32 v[10:11], v[38:39], v[38:39], v[10:11]
    v_pk_fma_f32 v[12:13], v[38:39], v[54:55], v[12:13]
    v_pk_add_f32 v[8:9], v[8:9], v[44:45]
    v_pk_fma_f32 v[10:11], v[44:45], v[44:45], v[10:11]
    v_pk_fma_f32 v[12:13], v[44:45], v[60:61], v[12:13]
    v_pk_add_f32 v[8:9], v[8:9], v[46:47]
    v_pk_fma_f32 v[10:11], v[46:47], v[46:47], v[10:11]
    v_pk_fma_f32 v[12:13], v[46:47], v[62:63], v[12:13]
    v_pk_add_f32 v[8:9], v[8:9], v[32:33]
    v_pk_fma_f32 v[10:11], v[32:33], v[32:33], v[10:11]
    v_pk_fma_f32 v[12:13], v[32:33], v[48:49], v[12:13]
    v_pk_add_f32 v[8:9], v[8:9], v[34:35]
    v_pk_fma_f32 v[10:11], v[34:35], v[34:35], v[10:11]
    v_pk_fma_f32 v[12:13], v[34:35], v[50:51], v[12:13]
    v_pk_add_f32 v[8:9], v[8:9], v[40:41]
    v_pk_fma_f32 v[10:11], v[40:41], v[40:41], v[10:11]
    v_pk_fma_f32 v[12:13], v[40:41], v[56:57], v[12:13]
    v_pk_add_f32 v[8:9], v[8:9], v[42:43]
    v_pk_fma_f32 v[10:11], v[42:43], v[42:43], v[10:11]
    v_pk_fma_f32 v[12:13], v[42:43], v[58:59], v[12:13]
    s_setprio 1
    v_permlane32_swap_b32 v8, v9
    v_permlane32_swap_b32 v10, v11
    v_permlane32_swap_b32 v12, v13
    v_add_f32 v8, v8, v9
    v_add_f32 v10, v10, v11
    v_add_f32 v12, v12, v13
    s_nop 0
    v_permlane16_swap_b32 v8, v10
    v_add_f32 v10, v8, v10
    v_add_f32_dpp v12, v12, v12 row_ror:8 row_mask:0xf bank_mask:0xf
    s_nop 0
    v_add_f32_dpp v10, v10, v10 row_ror:8 row_mask:0xf bank_mask:0xf
    v_add_f32_dpp v12, v12, v12 row_ror:4 row_mask:0xf bank_mask:0xf
    s_nop 0
    v_add_f32_dpp v10, v10, v10 row_ror:4 row_mask:0xf bank_mask:0xf
    v_add_f32_dpp v12, v12, v12 row_ror:2 row_mask:0xf bank_mask:0xf
    s_nop 0
    v_add_f32_dpp v10, v10, v10 row_ror:2 row_mask:0xf bank_mask:0xf
    v_add_f32_dpp v12, v12, v12 row_ror:1 row_mask:0xf bank_mask:0xf
    s_nop 0
    v_add_f32_dpp v10, v10, v10 row_ror:1 row_mask:0xf bank_mask:0xf
    v_add_f32_dpp v12, v12, v12 row_bcast:15 row_mask:0xa bank_mask:0xf
    v_mul_f32 v10, 0x3b000000, v10
    s_nop 1
    v_mov_b32_dpp v8, v10 row_bcast:15 row_mask:0xa bank_mask:0xf
    v_fma_f32 v10, -v8, v8, v10
    v_max_f32 v10, 0, v10
    v_add_f32 v11, 0x3727c5ac, v10
    v_rsq_f32 v9, v11
    s_nop 0
    v_mul_f32 v138, v12, v9
    v_ashrrev_i32 v13, 31, v138
    v_bitop3_b32 v13, v13, v138, s28 bitop3:0x36
    v_and_or_b32 v12, v13, s29, v243
    s_mov_b64 exec, s[44:45]
    ds_max_u32 v246, v12 offset:0
    s_mov_b32 exec_hi, 0
    ds_add_rtn_u32 v13, v246, v248 offset:24
    ds_read_b32 v18, v246 offset:0
    s_waitcnt lgkmcnt(1)
    v_cmp_eq_u32 vcc, 7, v13
    s_waitcnt lgkmcnt(0)
    v_xor_b32 v19, 0x5a17c3e9, v18
    s_cbranch_vccz L_nokey_46
    buffer_store_dwordx2 v[18:19], v247, s[24:27], s36 offen sc1
L_nokey_46:
    s_mov_b64 exec, -1
    s_setprio 0
    s_barrier
    ds_read_b32 v14, v246 offset:0
    v_mul_f32 v17, v8, v9
    v_readlane_b32 s52, v9, 16
    v_readlane_b32 s53, v9, 48
    v_readlane_b32 s54, v17, 16
    v_readlane_b32 s55, v17, 48
    v_mov_b32 v139, v12
    s_waitcnt lgkmcnt(0)
    v_cmp_eq_u32 vcc, v14, v12
    v_mov_b32 v20, s54
    v_mov_b32 v21, s55
    s_and_b64 s[50:51], vcc, s[44:45]
    s_cselect_b32 s64, 1, 0
    s_cbranch_scc0 L_noz_47
    s_setprio 3
    s_cmp_eq_u32 s50, 0
    s_cbranch_scc1 L_zb_48
    v_fma_f32 v144, v32, s52, -v20
    v_fma_f32 v145, v34, s52, -v20
    v_cvt_pk_bf16_f32 v152, v144, v145
    ds_write_b16 v226, v152 offset:0
    ds_write_b16_d16_hi v226, v152 offset:256
    v_fma_f32 v146, v36, s52, -v20
    v_fma_f32 v147, v38, s52, -v20
    v_cvt_pk_bf16_f32 v153, v146, v147
    ds_write_b16 v226, v153 offset:32
    ds_write_b16_d16_hi v226, v153 offset:288
    v_fma_f32 v148, v40, s52, -v20
    v_fma_f32 v149, v42, s52, -v20
    v_cvt_pk_bf16_f32 v154, v148, v149
    ds_write_b16 v226, v154 offset:512
    ds_write_b16_d16_hi v226, v154 offset:768
    v_fma_f32 v150, v44, s52, -v20
    v_fma_f32 v151, v46, s52, -v20
    v_cvt_pk_bf16_f32 v155, v150, v151
    ds_write_b16 v226, v155 offset:544
    ds_write_b16_d16_hi v226, v155 offset:800
L_zj_49:
    ds_read_b128 v[168:171], v229
    v_mul_f32 v138, 0xbfb8aa3b, v138
    v_exp_f32 v138, v138
    v_add_f32 v16, 1.0, v9
    v_mul_f32 v15, v16, v16
    v_fmaak_f32 v15, v15, v10, 0x3727c5ac
    v_rsq_f32 v15, v15
    v_mul_f32 v18, v11, v9
    v_mul_f32 v15, v15, v16
    v_add_f32 v136, 1.0, v18
    v_mul_f32 v137, v15, v18
    v_add_f32 v138, 1.0, v138
    v_rcp_f32 v138, v138
    s_waitcnt lgkmcnt(0)
    buffer_store_dwordx4 v[168:171], v5, s[24:27], s37 offen sc1
    s_mov_b64 exec, s[50:51]
    buffer_store_dwordx4 v[136:139], v247, s[24:27], s37 offen offset:1024 sc1
    s_mov_b64 exec, -1
    s_setprio 0
    s_branch L_zd_50
L_zb_48:
    v_fma_f32 v144, v33, s53, -v21
    v_fma_f32 v145, v35, s53, -v21
    v_cvt_pk_bf16_f32 v152, v144, v145
    ds_write_b16 v228, v152
    ds_write_b16_d16_hi v227, v152 offset:544
    v_fma_f32 v146, v37, s53, -v21
    v_fma_f32 v147, v39, s53, -v21
    v_cvt_pk_bf16_f32 v153, v146, v147
    ds_write_b16 v227, v153 offset:768
    ds_write_b16_d16_hi v227, v153 offset:512
    v_fma_f32 v148, v41, s53, -v21
    v_fma_f32 v149, v43, s53, -v21
    v_cvt_pk_bf16_f32 v154, v148, v149
    ds_write_b16 v227, v154 offset:288
    ds_write_b16_d16_hi v227, v154 offset:32
    v_fma_f32 v150, v45, s53, -v21
    v_fma_f32 v151, v47, s53, -v21
    v_cvt_pk_bf16_f32 v155, v150, v151
    ds_write_b16 v227, v155 offset:256
    ds_write_b16_d16_hi v227, v155 offset:0
    s_branch L_zj_49
L_noz_47:
    v_add_f32 v16, 1.0, v9
    v_mul_f32 v15, v16, v16
    v_fmaak_f32 v15, v15, v10, 0x3727c5ac
    v_rsq_f32 v15, v15
    v_mul_f32 v18, v11, v9
    v_mul_f32 v15, v15, v16
    v_add_f32 v136, 1.0, v18
    v_mul_f32 v137, v15, v18
L_zd_50:
    v_readlane_b32 s48, v8, 16
    v_readlane_b32 s49, v8, 48
    v_readlane_b32 s46, v15, 16
    v_readlane_b32 s47, v15, 48
    v_mov_b32 v18, s48
    v_mov_b32 v19, s49
    v_pk_mul_f32 v[18:19], v[18:19], s[46:47]
    v_pk_fma_f32 v[160:161], v[32:33], s[46:47], v[18:19] neg_lo:[0,0,1] neg_hi:[0,0,1]
    v_pk_fma_f32 v[162:163], v[34:35], s[46:47], v[18:19] neg_lo:[0,0,1] neg_hi:[0,0,1]
    v_pk_fma_f32 v[164:165], v[36:37], s[46:47], v[18:19] neg_lo:[0,0,1] neg_hi:[0,0,1]
    v_pk_fma_f32 v[166:167], v[38:39], s[46:47], v[18:19] neg_lo:[0,0,1] neg_hi:[0,0,1]
    v_pk_fma_f32 v[168:169], v[40:41], s[46:47], v[18:19] neg_lo:[0,0,1] neg_hi:[0,0,1]
    v_pk_fma_f32 v[170:171], v[42:43], s[46:47], v[18:19] neg_lo:[0,0,1] neg_hi:[0,0,1]
    v_pk_fma_f32 v[172:173], v[44:45], s[46:47], v[18:19] neg_lo:[0,0,1] neg_hi:[0,0,1]
    v_pk_fma_f32 v[174:175], v[46:47], s[46:47], v[18:19] neg_lo:[0,0,1] neg_hi:[0,0,1]
    v_add_f32 v160, v160, v161
    v_add_f32 v162, v162, v163
    v_cvt_pk_f16_f32 v152, v160, v162
    v_add_f32 v164, v164, v165
    v_add_f32 v166, v166, v167
    v_cvt_pk_f16_f32 v153, v164, v166
    v_add_f32 v168, v168, v169
    v_add_f32 v170, v170, v171
    v_cvt_pk_f16_f32 v154, v168, v170
    v_add_f32 v172, v172, v173
    v_add_f32 v174, v174, v175
    v_cvt_pk_f16_f32 v155, v172, v174
    v_mov_b32 v156, v152
    v_xor_b32 v157, 0x80008000, v153
    v_mfma_f32_16x16x32_f16 v[176:179], v[152:155], v[64:67], 0
    v_mov_b32 v158, v154
    v_xor_b32 v159, 0x80008000, v155
    v_mfma_f32_16x16x32_f16 v[180:183], v[152:155], v[68:71], 0
    s_nop 0
    v_mfma_f32_16x16x32_f16 v[184:187], v[156:159], v[64:67], 0
    v_mfma_f32_16x16x32_f16 v[188:191], v[156:159], v[68:71], 0
    s_nop 1
    v_cvt_pk_f16_f32 v20, v176, v177
    v_cvt_pk_f16_f32 v21, v178, v179
    s_nop 0
    v_cvt_pk_f16_f32 v22, v180, v181
    v_cvt_pk_f16_f32 v23, v182, v183
    v_pk_mul_f16 v144, v20, v80
    v_pk_mul_f16 v146, v22, v80
    v_pk_mul_f16 v145, v21, v81
    v_pk_mul_f16 v147, v23, v81
    v_pk_fma_f16 v144, v22, v82, v144
    v_pk_fma_f16 v146, v20, v82, v146 neg_lo:[1,0,0] neg_hi:[1,0,0]
    v_pk_fma_f16 v145, v23, v83, v145
    v_pk_fma_f16 v147, v21, v83, v147 neg_lo:[1,0,0] neg_hi:[1,0,0]
    s_nop 1
    v_mfma_f32_16x16x32_f16 v[160:163], v[72:75], v[144:147], 0
    v_mfma_f32_16x16x32_f16 v[168:171], v[76:79], v[144:147], 0
    v_cvt_pk_f16_f32 v20, v184, v185
    v_cvt_pk_f16_f32 v21, v186, v187
    v_cvt_pk_f16_f32 v22, v188, v189
    v_cvt_pk_f16_f32 v23, v190, v191
    v_pk_mul_f16 v148, v20, v84
    v_pk_mul_f16 v150, v22, v84
    v_pk_mul_f16 v149, v21, v85
    v_pk_mul_f16 v151, v23, v85
    v_pk_fma_f16 v148, v22, v86, v148
    v_pk_fma_f16 v150, v20, v86, v150 neg_lo:[1,0,0] neg_hi:[1,0,0]
    v_pk_fma_f16 v149, v23, v87, v149
    v_pk_fma_f16 v151, v21, v87, v151 neg_lo:[1,0,0] neg_hi:[1,0,0]
    s_nop 1
    v_mfma_f32_16x16x32_f16 v[164:167], v[72:75], v[148:151], 0
    v_cndmask_b32_e64 v160, v160, v168, s[58:59]
    v_cvt_pk_f16_f32 v20, v160, v161
    v_cvt_pk_f16_f32 v21, v162, v163
    ds_write_b32 v230, v20 offset:24576
    ds_write_b32 v230, v21 offset:28736
    s_nop 2
    v_cvt_pk_f16_f32 v22, v164, v165
    v_cvt_pk_f16_f32 v23, v166, v167
    ds_write_b32 v230, v22 offset:24640
    ds_write_b32 v230, v23 offset:28800
    v_add_u32 v28, 1040, v231
    s_cmp_ge_u32 s3, 4
    s_cbranch_scc1 L_sAh_51
    s_waitcnt lgkmcnt(0)
    s_barrier
    ds_read2_b32 v[20:21], v231 offset0:0 offset1:130
    ds_read2_b32 v[22:23], v28 offset0:0 offset1:130
    ds_read2_b32 v[24:25], v231 offset0:64 offset1:194
    ds_read2_b32 v[26:27], v28 offset0:64 offset1:194
    s_waitcnt lgkmcnt(2)
    v_or_b32 v20, 1, v20
    buffer_store_dwordx4 v[20:23], v234, s[24:27], 0 offen sc1
    s_waitcnt lgkmcnt(0)
    v_or_b32 v24, 1, v24
    buffer_store_dwordx4 v[24:27], v234, s[24:27], s81 offen sc1
    s_branch L_sAj_52
L_sAh_51:
    s_waitcnt vmcnt(2)
    s_cmp_eq_u32 s64, 0
    s_cbranch_scc0 L_only_53
    s_waitcnt vmcnt(0)
L_only_53:
    s_waitcnt lgkmcnt(0)
    s_barrier
L_sAj_52:
    s_mul_i32 s36, s2, 32
    s_add_u32 s36, s36, 2114560
    s_mul_i32 s37, s2, 1152
    s_add_u32 s37, s37, 2307968
    ds_read_b128 v[64:67], v253 offset:7168
    ds_read_b128 v[68:71], v253 offset:8192
    ds_read_b128 v[80:83], v253 offset:9216
    ds_read_b128 v[84:87], v253 offset:10240
    v_pk_fma_f32 v[32:33], v[32:33], s[52:53], v[32:33]
    v_pk_fma_f32 v[34:35], v[34:35], s[52:53], v[34:35]
    v_pk_fma_f32 v[36:37], v[36:37], s[52:53], v[36:37]
    v_pk_fma_f32 v[38:39], v[38:39], s[52:53], v[38:39]
    v_pk_fma_f32 v[40:41], v[40:41], s[52:53], v[40:41]
    v_pk_fma_f32 v[42:43], v[42:43], s[52:53], v[42:43]
    v_pk_fma_f32 v[44:45], v[44:45], s[52:53], v[44:45]
    v_pk_fma_f32 v[46:47], v[46:47], s[52:53], v[46:47]
    v_pk_add_f32 v[224:225], v[224:225], s[54:55] neg_lo:[0,1] neg_hi:[0,1]
    s_waitcnt lgkmcnt(2)
    v_xor_b32 v72, 0x80000000, v64
    v_xor_b32 v73, 0x80000000, v65
    v_xor_b32 v74, 0x80000000, v66
    v_xor_b32 v75, 0x80000000, v67
    v_xor_b32 v76, 0x80000000, v68
    v_xor_b32 v77, 0x80000000, v69
    v_xor_b32 v78, 0x80000000, v70
    v_xor_b32 v79, 0x80000000, v71
    s_cmp_ge_u32 s3, 4
    s_cbranch_scc1 L_cH_54
    s_cmp_eq_u32 s3, 0
    s_cbranch_scc0 L_only_59
    s_mov_b32 s76, 2097152
    v_mov_b32 v11, 1024
    v_mul_u32_u24 v8, 32, v1
    v_add_u32 v9, 2048, v8
    v_mov_b32 v10, 4096
    v_add_u32 v22, 148224, v5
    s_sleep 8
    s_mov_b32 s70, 262144
    s_branch L_kl_61
L_kr_60:
    s_sub_u32 s70, s70, 1
    s_cbranch_scc1 L_kd_62
    s_mov_b64 exec, vcc
L_kl_61:
    buffer_load_dwordx2 v[16:17], v8, s[24:27], s76 offen sc1
    buffer_load_dwordx2 v[18:19], v9, s[24:27], s76 offen sc1
    buffer_load_dwordx2 v[20:21], v10, s[24:27], s76 offen sc1
    s_mov_b64 exec, -1
    s_waitcnt vmcnt(0)
    v_max3_u32 v31, v16, v18, v20
    v_bitop3_b32 v12, v16, v17, s43 bitop3:0x96
    v_bitop3_b32 v13, v18, v19, s43 bitop3:0x96
    v_max_u32_dpp v31, v31, v31 row_ror:8 row_mask:0xf bank_mask:0xf
    v_bitop3_b32 v14, v20, v21, s43 bitop3:0x96
    v_or3_b32 v12, v12, v13, v14
    v_max_u32_dpp v31, v31, v31 row_ror:4 row_mask:0xf bank_mask:0xf
    v_cmp_ne_u32 vcc, 0, v12
    s_nop 0
    v_max_u32_dpp v31, v31, v31 row_ror:2 row_mask:0xf bank_mask:0xf
    s_nop 1
    v_max_u32_dpp v31, v31, v31 row_ror:1 row_mask:0xf bank_mask:0xf
    s_nop 1
    v_max_u32_dpp v31, v31, v31 row_bcast:15 row_mask:0xa bank_mask:0xf
    s_cbranch_vccnz L_kr_60
    s_nop 0
    v_max_u32_dpp v31, v31, v31 row_bcast:31 row_mask:0xc bank_mask:0xf
L_kd_62:
    s_nop 0
    v_readlane_b32 s71, v31, 63
    s_andn2_b32 s72, 2047, s71
    s_and_b32 s73, s72, 255
    s_sub_u32 s65, 256, s73
    s_min_u32 s73, s73, s65
    s_mul_i32 s76, s73, 1152
    s_add_u32 s76, s76, 2159360
    s_mov_b32 s70, 262144
    buffer_load_dwordx4 v[12:15], v5, s[24:27], s76 offen sc1
    buffer_load_dwordx4 v[16:19], v11, s[24:27], s76 offen sc1
    s_branch L_pollc_65
L_retry_63:
    s_sub_u32 s70, s70, 1
    s_cbranch_scc1 L_polld_66
    s_mov_b64 exec, vcc
L_poll_64:
    buffer_load_dwordx4 v[12:15], v5, s[24:27], s76 offen sc1
    buffer_load_dwordx4 v[16:19], v11, s[24:27], s76 offen sc1
L_pollc_65:
    s_waitcnt vmcnt(0)
    ds_write_b128 v22, v[12:15]
    s_mov_b64 s[50:51], exec
    s_and_b64 exec, exec, 1
    ds_write_b128 v22, v[16:19] offset:1024
    s_mov_b64 exec, s[50:51]
    v_max3_u32 v31, v12, v13, v14
    v_max3_u32 v31, v31, v15, v16
    v_max3_u32 v31, v31, v17, v18
    v_max_u32 v31, v31, v19
    v_cmp_eq_u32 vcc, -1, v31
    s_cbranch_vccnz L_retry_63
L_polld_66:
    s_mov_b64 exec, -1
L_only_59:
    s_cmp_eq_u32 s2, 128
    s_cbranch_scc1 L_c128_55
    s_setprio 2
    s_waitcnt lgkmcnt(0)
    s_barrier
    ds_read_b128 v[152:155], v237 offset:41728
    ds_read_b128 v[156:159], v237 offset:42752
    ds_read_b128 v[144:147], v237 offset:41472
    ds_read_b128 v[148:151], v237 offset:42496
    ds_read_b128 v[160:163], v239 offset:41472
    ds_read_b128 v[172:175], v238 offset:41728
    ds_read_b128 v[176:179], v238 offset:42752
    ds_read_b128 v[164:167], v238 offset:41472
    ds_read_b128 v[168:171], v238 offset:42496
    ds_read_b128 v[180:183], v240 offset:41472
    s_waitcnt lgkmcnt(9)
    v_mfma_f32_16x16x32_f16 v[192:195], v[152:155], v[88:91], 0
    v_mfma_f32_16x16x32_f16 v[196:199], v[152:155], v[92:95], 0
    s_waitcnt lgkmcnt(8)
    v_mfma_f32_16x16x32_f16 v[192:195], v[156:159], v[96:99], v[192:195]
    v_mfma_f32_16x16x32_f16 v[196:199], v[156:159], v[100:103], v[196:199]
    s_waitcnt lgkmcnt(7)
    v_mfma_f32_16x16x32_f16 v[184:187], v[144:147], v[88:91], 0
    s_nop 1
    v_mfma_f32_16x16x32_f16 v[188:191], v[144:147], v[92:95], 0
    s_waitcnt lgkmcnt(3)
    v_mfma_f32_16x16x32_f16 v[184:187], v[148:151], v[96:99], v[184:187]
    v_cvt_pk_f16_f32 v24, v192, v193
    v_cvt_pk_f16_f32 v25, v194, v195
    v_mfma_f32_16x16x32_f16 v[188:191], v[148:151], v[100:103], v[188:191]
    v_cvt_pk_f16_f32 v26, v196, v197
    v_cvt_pk_f16_f32 v27, v198, v199
    v_mfma_f32_16x16x32_f16 v[184:187], v[160:163], v[104:107], v[184:187]
    v_pk_mul_f16 v152, v24, v116
    v_pk_mul_f16 v154, v26, v116
    v_mfma_f32_16x16x32_f16 v[188:191], v[160:163], v[108:111], v[188:191]
    v_pk_mul_f16 v153, v25, v117
    v_pk_mul_f16 v155, v27, v117
    v_mfma_f32_16x16x32_f16 v[208:211], v[172:175], v[88:91], 0
    v_pk_fma_f16 v152, v26, v118, v152
    v_pk_fma_f16 v154, v24, v118, v154 neg_lo:[1,0,0] neg_hi:[1,0,0]
    v_mfma_f32_16x16x32_f16 v[212:215], v[172:175], v[92:95], 0
    v_pk_fma_f16 v153, v27, v119, v153
    v_pk_fma_f16 v155, v25, v119, v155 neg_lo:[1,0,0] neg_hi:[1,0,0]
    v_mfma_f32_16x16x32_f16 v[208:211], v[176:179], v[96:99], v[208:211]
    v_cvt_pk_f16_f32 v20, v184, v185
    v_cvt_pk_f16_f32 v21, v186, v187
    v_mfma_f32_16x16x32_f16 v[212:215], v[176:179], v[100:103], v[212:215]
    v_cvt_pk_f16_f32 v22, v188, v189
    v_cvt_pk_f16_f32 v23, v190, v191
    s_waitcnt lgkmcnt(0)
    v_mfma_f32_16x16x32_f16 v[200:203], v[164:167], v[88:91], 0
    v_pk_mul_f16 v156, v20, v112
    v_pk_mul_f16 v158, v22, v112
    v_mfma_f32_16x16x32_f16 v[204:207], v[164:167], v[92:95], 0
    v_pk_mul_f16 v157, v21, v113
    v_pk_mul_f16 v159, v23, v113
    v_mfma_f32_16x16x32_f16 v[200:203], v[168:171], v[96:99], v[200:203]
    v_pk_fma_f16 v156, v22, v114, v156
    v_pk_fma_f16 v158, v20, v114, v158 neg_lo:[1,0,0] neg_hi:[1,0,0]
    v_mfma_f32_16x16x32_f16 v[204:207], v[168:171], v[100:103], v[204:207]
    v_pk_fma_f16 v157, v23, v115, v157
    v_pk_fma_f16 v159, v21, v115, v159 neg_lo:[1,0,0] neg_hi:[1,0,0]
    v_mfma_f32_16x16x32_f16 v[200:203], v[180:183], v[104:107], v[200:203]
    v_cvt_pk_f16_f32 v24, v208, v209
    v_cvt_pk_f16_f32 v25, v210, v211
    v_mfma_f32_16x16x32_f16 v[204:207], v[180:183], v[108:111], v[204:207]
    v_cvt_pk_f16_f32 v26, v212, v213
    v_cvt_pk_f16_f32 v27, v214, v215
    v_mfma_f32_16x16x32_f16 v[216:219], v[124:127], v[152:155], 0
    v_pk_mul_f16 v144, v24, v116
    v_pk_mul_f16 v146, v26, v116
    v_mfma_f32_16x16x32_f16 v[220:223], v[132:135], v[152:155], 0
    v_pk_mul_f16 v145, v25, v117
    v_pk_mul_f16 v147, v27, v117
    v_mfma_f32_16x16x32_f16 v[216:219], v[120:123], v[156:159], v[216:219]
    v_pk_fma_f16 v144, v26, v118, v144
    v_pk_fma_f16 v146, v24, v118, v146 neg_lo:[1,0,0] neg_hi:[1,0,0]
    v_mfma_f32_16x16x32_f16 v[220:223], v[128:131], v[156:159], v[220:223]
    v_pk_fma_f16 v145, v27, v119, v145
    v_pk_fma_f16 v147, v25, v119, v147 neg_lo:[1,0,0] neg_hi:[1,0,0]
    v_cvt_pk_f16_f32 v20, v200, v201
    v_cvt_pk_f16_f32 v21, v202, v203
    v_mfma_f32_16x16x32_f16 v[184:187], v[124:127], v[144:147], 0
    v_cvt_pk_f16_f32 v22, v204, v205
    v_cvt_pk_f16_f32 v23, v206, v207
    v_pk_mul_f16 v148, v20, v112
    v_pk_mul_f16 v150, v22, v112
    v_pk_mul_f16 v149, v21, v113
    v_mfma_f32_16x16x32_f16 v[188:191], v[132:135], v[144:147], 0
    v_pk_mul_f16 v151, v23, v113
    v_pk_fma_f16 v148, v22, v114, v148
    v_pk_fma_f16 v150, v20, v114, v150 neg_lo:[1,0,0] neg_hi:[1,0,0]
    v_pk_fma_f16 v149, v23, v115, v149
    v_pk_fma_f16 v151, v21, v115, v151 neg_lo:[1,0,0] neg_hi:[1,0,0]
    s_nop 1
    v_mfma_f32_16x16x32_f16 v[184:187], v[120:123], v[148:151], v[184:187]
    v_mfma_f32_16x16x32_f16 v[188:191], v[128:131], v[148:151], v[188:191]
    s_nop 6
    v_cvt_pk_f16_f32 v8, v216, v184
    v_cvt_pk_f16_f32 v9, v217, v185
    v_cvt_pk_f16_f32 v10, v218, v186
    v_cvt_pk_f16_f32 v11, v219, v187
    ds_write_b128 v241, v[8:11] offset:50688
    v_cvt_pk_f16_f32 v12, v220, v188
    v_cvt_pk_f16_f32 v13, v221, v189
    v_cvt_pk_f16_f32 v14, v222, v190
    v_cvt_pk_f16_f32 v15, v223, v191
    ds_write_b128 v241, v[12:15] offset:54912
    s_mov_b64 exec, 1
    ds_add_u32 v246, v248 offset:8
    s_mov_b64 exec, -1
L_m4_68:
    ds_read_b32 v24, v246 offset:8
    ds_read_b128 v[12:15], v242 offset:50688
    ds_read_b128 v[16:19], v255 offset:50688
    ds_read_b128 v[20:23], v242 offset:52736
    s_waitcnt lgkmcnt(3)
    v_cmp_gt_u32 vcc, 4, v24
    s_cbranch_vccnz L_m4_68
    s_waitcnt lgkmcnt(2)
    v_or_b32 v12, 1, v12
    buffer_store_dwordx4 v[12:15], v235, s[24:27], 0 offen sc1
    s_waitcnt lgkmcnt(1)
    v_or_b32 v16, 1, v16
    buffer_store_dwordx4 v[16:19], v235, s[24:27], s82 offen sc1
    s_waitcnt lgkmcnt(0)
    s_cmp_eq_u32 s3, 0
    s_cbranch_scc0 L_only_69
    s_mov_b64 exec, 0xf
    s_mov_b32 s76, 1048576
    v_or_b32 v20, 1, v20
    buffer_store_dwordx4 v[20:23], v235, s[24:27], s76 offen sc1
    s_mov_b64 exec, -1
L_only_69:
    s_branch L_cjoin_58
L_c128_55:
    s_waitcnt lgkmcnt(0)
    s_barrier
    s_branch L_cjoin_58
L_cH_54:
    ds_read_b128 v[164:167], v253 offset:11264
    ds_read_b128 v[168:171], v253 offset:12288
    ds_read_b128 v[172:175], v253 offset:13312
    ds_read_b128 v[176:179], v253 offset:14336
    s_mul_i32 s64, s2, 147
    s_lshr_b32 s64, s64, 12
    s_mul_i32 s64, s64, 28
    s_sub_u32 s64, s2, s64
    s_lshl_b32 s64, s64, 7
    s_add_u32 s76, s64, 2139136
    s_cmp_eq_u32 s2, 128
    s_cbranch_scc1 L_cHb_56
    s_setprio 3
    s_cmp_eq_u32 s3, 4
    s_cbranch_scc0 L_only_70
    v_and_b32 v8, 48, v5
    v_add_u32 v8, 8192, v8
    s_mov_b32 s70, 262144
    s_sleep 16
    s_branch L_poll_72
L_retry_71:
    s_sub_u32 s70, s70, 1
    s_cbranch_scc1 L_polld_74
    s_mov_b64 exec, vcc
L_poll_72:
    buffer_load_dwordx4 v[12:15], v4, s[24:27], s77 offen sc1
    buffer_load_dwordx4 v[16:19], v4, s[24:27], s79 offen sc1
    buffer_load_dwordx4 v[20:23], v8, s[24:27], s77 offen sc1
L_pollc_73:
    s_waitcnt vmcnt(0)
    ds_write_b128 v236, v[12:15] offset:41472
    ds_write_b128 v236, v[16:19] offset:42496
    s_mov_b64 s[50:51], exec
    s_and_b64 exec, exec, 0xf
    ds_write_b128 v236, v[20:23] offset:43520
    s_mov_b64 exec, s[50:51]
    v_max3_u32 v31, v12, v13, v14
    v_max3_u32 v31, v31, v15, v16
    v_max3_u32 v31, v31, v17, v18
    v_max3_u32 v31, v31, v19, v20
    v_max3_u32 v31, v31, v21, v22
    v_max_u32 v31, v31, v23
    v_cmp_eq_u32 vcc, -1, v31
    s_cbranch_vccnz L_retry_71
L_polld_74:
    s_mov_b64 exec, -1
    s_waitcnt lgkmcnt(0)
    s_barrier
    s_branch L_cHc_57
L_only_70:
    s_mov_b32 s70, 262144
    s_sleep 16
    s_branch L_poll_77
L_retry_76:
    s_sub_u32 s70, s70, 1
    s_cbranch_scc1 L_polld_79
    s_mov_b64 exec, vcc
L_poll_77:
    buffer_load_dwordx4 v[12:15], v4, s[24:27], s77 offen sc1
    buffer_load_dwordx4 v[16:19], v4, s[24:27], s79 offen sc1
L_pollc_78:
    s_waitcnt vmcnt(0)
    ds_write_b128 v236, v[12:15] offset:41472
    ds_write_b128 v236, v[16:19] offset:42496
    v_max3_u32 v31, v12, v13, v14
    v_max3_u32 v31, v31, v15, v16
    v_max3_u32 v31, v31, v17, v18
    v_max_u32 v31, v31, v19
    v_cmp_eq_u32 vcc, -1, v31
    s_cbranch_vccnz L_retry_76
L_polld_79:
    s_mov_b64 exec, -1
L_cHb_56:
    s_waitcnt lgkmcnt(0)
    s_barrier
L_cHc_57:
    s_setprio 0
    v_mov_b32 v30, 148224
    buffer_load_dwordx2 v[10:11], v247, s[24:27], s76 offen sc1
    ds_read_b128 v[24:27], v30 offset:1024
    ds_read_b64_tr_b16 v[216:217], v254
    ds_read_b64_tr_b16 v[218:219], v254 offset:32
    v_add_u32 v9, 148224, v250
    ds_read_u16_d16_hi v104, v9 offset:0
    ds_read_u16_d16_hi v105, v9 offset:256
    ds_read_u16_d16_hi v106, v9 offset:512
    ds_read_u16_d16_hi v107, v9 offset:768
    s_waitcnt lgkmcnt(6)
    v_readfirstlane_b32 s71, v27
    s_andn2_b32 s72, 2047, s71
    s_and_b32 s73, s72, 255
    s_sub_u32 s65, 256, s73
    s_min_u32 s73, s73, s65
    s_mul_i32 s64, s40, s72
    s_and_b32 s64, s64, 2047
    v_cvt_f32_u32 v28, s64
    v_mul_f32 v28, 0x3a000000, v28
    v_sin_f32 v30, v28
    v_cos_f32 v28, v28
    s_waitcnt lgkmcnt(0)
    v_mul_f32 v104, v104, v24
    v_mul_f32 v105, v105, v24
    v_mul_f32 v106, v106, v24
    v_mul_f32 v107, v107, v24
    v_mov_b32 v24, v25
    v_pk_mul_f32 v[88:89], v[164:165], v[28:29] op_sel_hi:[1,0]
    v_pk_mul_f32 v[92:93], v[168:169], v[28:29] op_sel_hi:[1,0]
    v_pk_fma_f32 v[88:89], v[168:169], v[30:31], v[88:89] op_sel_hi:[1,0,1] neg_lo:[1,0,0] neg_hi:[1,0,0]
    v_pk_fma_f32 v[92:93], v[164:165], v[30:31], v[92:93] op_sel_hi:[1,0,1]
    v_pk_mul_f32 v[90:91], v[166:167], v[28:29] op_sel_hi:[1,0]
    v_pk_mul_f32 v[94:95], v[170:171], v[28:29] op_sel_hi:[1,0]
    v_pk_fma_f32 v[90:91], v[170:171], v[30:31], v[90:91] op_sel_hi:[1,0,1] neg_lo:[1,0,0] neg_hi:[1,0,0]
    v_pk_fma_f32 v[94:95], v[166:167], v[30:31], v[94:95] op_sel_hi:[1,0,1]
    v_pk_mul_f32 v[96:97], v[172:173], v[28:29] op_sel_hi:[1,0]
    v_pk_mul_f32 v[100:101], v[176:177], v[28:29] op_sel_hi:[1,0]
    v_pk_fma_f32 v[96:97], v[176:177], v[30:31], v[96:97] op_sel_hi:[1,0,1] neg_lo:[1,0,0] neg_hi:[1,0,0]
    v_pk_fma_f32 v[100:101], v[172:173], v[30:31], v[100:101] op_sel_hi:[1,0,1]
    v_pk_mul_f32 v[98:99], v[174:175], v[28:29] op_sel_hi:[1,0]
    v_pk_mul_f32 v[102:103], v[178:179], v[28:29] op_sel_hi:[1,0]
    v_pk_fma_f32 v[98:99], v[178:179], v[30:31], v[98:99] op_sel_hi:[1,0,1] neg_lo:[1,0,0] neg_hi:[1,0,0]
    v_pk_fma_f32 v[102:103], v[174:175], v[30:31], v[102:103] op_sel_hi:[1,0,1]
L_cjoin_58:
    s_setprio 0
    s_cmp_ge_u32 s3, 4
    s_cbranch_scc1 L_y2h_81
    v_mov_b32 v30, 148224
    ds_read_b32 v8, v30 offset:1036
    v_add_u32 v28, 8448, v231
    v_add_u32 v29, 9488, v231
    s_waitcnt lgkmcnt(0)
    v_readfirstlane_b32 s71, v8
    v_lshlrev_b32 v8, 31, v8
    v_xor_b32 v8, -1.0, v8
    s_andn2_b32 s72, 2047, s71
    s_and_b32 s73, s72, 255
    s_sub_u32 s65, 256, s73
    s_min_u32 s73, s73, s65
    s_setprio 1
    s_mov_b32 s70, 262144
    s_sleep 16
    s_branch L_poll_84
L_retry_83:
    s_sub_u32 s70, s70, 1
    s_cbranch_scc1 L_polld_86
    s_mov_b64 exec, vcc
L_poll_84:
    buffer_load_dwordx4 v[160:163], v4, s[24:27], s78 offen sc1
    buffer_load_dwordx4 v[164:167], v4, s[24:27], s80 offen sc1
L_pollc_85:
    s_waitcnt vmcnt(0)
    ds_write2_b32 v28, v160, v161 offset0:0 offset1:130
    ds_write2_b32 v29, v162, v163 offset0:0 offset1:130
    ds_write2_b32 v28, v164, v165 offset0:64 offset1:194
    ds_write2_b32 v29, v166, v167 offset0:64 offset1:194
    v_max3_u32 v31, v160, v161, v162
    v_max3_u32 v31, v31, v163, v164
    v_max3_u32 v31, v31, v165, v166
    v_max_u32 v31, v31, v167
    v_cmp_eq_u32 vcc, -1, v31
    s_cbranch_vccnz L_retry_83
L_polld_86:
    s_mov_b64 exec, -1
    s_setprio 0
    s_mov_b64 exec, 1
    ds_add_u32 v246, v248 offset:16
    s_mov_b64 exec, -1
L_m4_88:
    ds_read_b32 v24, v246 offset:16
    ds_read_b32 v17, v230 offset:33088
    ds_read_b32 v19, v233
    ds_read_b32 v16, v230 offset:33024
    ds_read_b32 v18, v232
    s_waitcnt lgkmcnt(4)
    v_cmp_gt_u32 vcc, 4, v24
    s_cbranch_vccnz L_m4_88
    s_waitcnt lgkmcnt(3)
    v_fma_mix_f32 v36, v17, s74, v36 op_sel:[0,0,0] op_sel_hi:[1,0,0]
    v_fma_mix_f32 v37, v17, s74, v37 op_sel:[0,0,0] op_sel_hi:[1,0,0]
    v_fma_mix_f32 v38, v17, s74, v38 op_sel:[1,0,0] op_sel_hi:[1,0,0]
    v_fma_mix_f32 v39, v17, s74, v39 op_sel:[1,0,0] op_sel_hi:[1,0,0]
    s_waitcnt lgkmcnt(2)
    v_fma_mix_f32 v44, v19, s74, v44 op_sel:[1,0,0] op_sel_hi:[1,0,0]
    v_fma_mix_f32 v45, v19, s74, v45 op_sel:[1,0,0] op_sel_hi:[1,0,0]
    v_fma_mix_f32 v46, v19, s74, v46 op_sel:[0,0,0] op_sel_hi:[1,0,0]
    v_fma_mix_f32 v47, v19, s74, v47 op_sel:[0,0,0] op_sel_hi:[1,0,0]
    s_waitcnt lgkmcnt(1)
    v_and_b32 v16, v244, v16
    v_fma_mix_f32 v32, v16, s74, v32 op_sel:[0,0,0] op_sel_hi:[1,0,0]
    v_fma_mix_f32 v33, v16, s74, v33 op_sel:[0,0,0] op_sel_hi:[1,0,0]
    v_fma_mix_f32 v34, v16, s74, v34 op_sel:[1,0,0] op_sel_hi:[1,0,0]
    v_fma_mix_f32 v35, v16, s74, v35 op_sel:[1,0,0] op_sel_hi:[1,0,0]
    s_waitcnt lgkmcnt(0)
    v_alignbit_b32 v18, v18, v18, v245
    v_fma_mix_f32 v40, v18, s74, v40 op_sel:[1,0,0] op_sel_hi:[1,0,0]
    v_fma_mix_f32 v41, v18, s74, v41 op_sel:[1,0,0] op_sel_hi:[1,0,0]
    v_fma_mix_f32 v42, v18, s74, v42 op_sel:[0,0,0] op_sel_hi:[1,0,0]
    v_fma_mix_f32 v43, v18, s74, v43 op_sel:[0,0,0] op_sel_hi:[1,0,0]
    s_cmp_eq_u32 s73, s2
    s_cbranch_scc1 L_rare_89
L_back_90:
    s_barrier
    ds_read_b128 v[144:147], v229 offset:12288
    ds_read_b128 v[148:151], v229 offset:13312
    s_cmp_eq_u32 s30, 1
    s_cbranch_scc0 L_only_91
    s_lshl_b32 s69, s2, 7
    s_add_u32 s69, s69, 2135552
    v_mov_b32 v28, 1
    v_mov_b32 v29, 0x5a17c3e8
    s_mov_b64 exec, 1
    buffer_store_dwordx2 v[28:29], v5, s[24:27], s69 offen sc1
    s_mov_b64 exec, -1
L_only_91:
    s_setprio 3
    s_waitcnt lgkmcnt(0)
    v_pk_fma_f32 v[34:35], v[144:145], v[8:9], v[34:35] op_sel:[1,0,0] op_sel_hi:[1,0,1]
    v_pk_fma_f32 v[36:37], v[146:147], v[8:9], v[36:37] op_sel:[0,0,0] op_sel_hi:[0,0,1]
    v_pk_fma_f32 v[38:39], v[146:147], v[8:9], v[38:39] op_sel:[1,0,0] op_sel_hi:[1,0,1]
    v_pk_fma_f32 v[40:41], v[148:149], v[8:9], v[40:41] op_sel:[0,0,0] op_sel_hi:[0,0,1]
    v_pk_fma_f32 v[42:43], v[148:149], v[8:9], v[42:43] op_sel:[1,0,0] op_sel_hi:[1,0,1]
    v_pk_fma_f32 v[44:45], v[150:151], v[8:9], v[44:45] op_sel:[0,0,0] op_sel_hi:[0,0,1]
    v_pk_fma_f32 v[46:47], v[150:151], v[8:9], v[46:47] op_sel:[1,0,0] op_sel_hi:[1,0,1]
    v_pk_fma_f32 v[32:33], v[144:145], v[8:9], v[32:33] op_sel:[0,0,0] op_sel_hi:[0,0,1]
    s_branch L_yj_82
L_rare_89:
    s_cmp_eq_u32 s40, s72
    s_cbranch_scc0 L_only_92
L_ow_93:
    ds_read_b32 v24, v246 offset:20
    s_waitcnt lgkmcnt(0)
    v_cmp_gt_u32 vcc, 4, v24
    s_cbranch_vccnz L_ow_93
    v_lshlrev_b32 v28, 7, v3
    v_lshl_add_u32 v28, v2, 2, v28
    ds_read_b32 v12, v28 offset:59136
    ds_read_b32 v13, v28 offset:59648
    ds_read_b32 v14, v28 offset:59200
    ds_read_b32 v15, v28 offset:59712
    ds_read_b32 v16, v28 offset:60160
    ds_read_b32 v17, v28 offset:60672
    ds_read_b32 v18, v28 offset:60224
    ds_read_b32 v19, v28 offset:60736
    s_waitcnt lgkmcnt(0)
    v_add_f32 v32, v32, v12
    v_add_f32 v34, v34, v13
    v_add_f32 v36, v36, v14
    v_add_f32 v38, v38, v15
    v_add_f32 v40, v40, v16
    v_add_f32 v42, v42, v17
    v_add_f32 v44, v44, v18
    v_add_f32 v46, v46, v19
L_only_92:
    s_cmp_eq_u32 s41, s72
    s_cbranch_scc0 L_only_94
L_ow_95:
    ds_read_b32 v24, v246 offset:20
    s_waitcnt lgkmcnt(0)
    v_cmp_gt_u32 vcc, 4, v24
    s_cbranch_vccnz L_ow_95
    v_lshlrev_b32 v28, 7, v3
    v_lshl_add_u32 v28, v2, 2, v28
    v_sub_u32 v28, 2048, v28
    v_and_b32 v29, 2047, v28
    ds_read_b32 v12, v29 offset:59136
    ds_read_b32 v13, v28 offset:58624
    ds_read_b32 v14, v28 offset:59072
    ds_read_b32 v15, v28 offset:58560
    ds_read_b32 v16, v28 offset:58112
    ds_read_b32 v17, v28 offset:57600
    ds_read_b32 v18, v28 offset:58048
    ds_read_b32 v19, v28 offset:57536
    s_waitcnt lgkmcnt(0)
    v_add_f32 v33, v33, v12
    v_add_f32 v35, v35, v13
    v_add_f32 v37, v37, v14
    v_add_f32 v39, v39, v15
    v_add_f32 v41, v41, v16
    v_add_f32 v43, v43, v17
    v_add_f32 v45, v45, v18
    v_add_f32 v47, v47, v19
L_only_94:
    s_nop 4
    s_branch L_back_90
L_rare_113:
    s_mov_b32 exec_hi, 0
    v_lshlrev_b32 v11, 1, v250
    v_sub_f32 v12, v220, v104
    ds_write_b32 v11, v12 offset:59136
    v_sub_f32 v13, v221, v105
    ds_write_b32 v11, v13 offset:59648
    v_sub_f32 v14, v222, v106
    ds_write_b32 v11, v14 offset:60160
    v_sub_f32 v15, v223, v107
    ds_write_b32 v11, v15 offset:60672
    s_mov_b64 exec, 1
    ds_add_u32 v246, v248 offset:20
    s_mov_b64 exec, -1
    s_nop 4
    s_branch L_back_114
L_rare_115:
    s_cmp_eq_u32 s40, s72
    s_cbranch_scc0 L_only_117
L_ow_118:
    ds_read_b32 v24, v246 offset:20
    s_waitcnt lgkmcnt(0)
    v_cmp_gt_u32 vcc, 4, v24
    s_cbranch_vccnz L_ow_118
    v_lshlrev_b32 v28, 7, v3
    v_lshl_add_u32 v28, v2, 2, v28
    ds_read_b32 v12, v28 offset:59136
    ds_read_b32 v13, v28 offset:59648
    ds_read_b32 v14, v28 offset:59200
    ds_read_b32 v15, v28 offset:59712
    ds_read_b32 v16, v28 offset:60160
    ds_read_b32 v17, v28 offset:60672
    ds_read_b32 v18, v28 offset:60224
    ds_read_b32 v19, v28 offset:60736
    s_waitcnt lgkmcnt(0)
    v_add_f32 v32, v32, v12
    v_add_f32 v34, v34, v13
    v_add_f32 v36, v36, v14
    v_add_f32 v38, v38, v15
    v_add_f32 v40, v40, v16
    v_add_f32 v42, v42, v17
    v_add_f32 v44, v44, v18
    v_add_f32 v46, v46, v19
L_only_117:
    s_cmp_eq_u32 s41, s72
    s_cbranch_scc0 L_only_119
L_ow_120:
    ds_read_b32 v24, v246 offset:20
    s_waitcnt lgkmcnt(0)
    v_cmp_gt_u32 vcc, 4, v24
    s_cbranch_vccnz L_ow_120
    v_lshlrev_b32 v28, 7, v3
    v_lshl_add_u32 v28, v2, 2, v28
    v_sub_u32 v28, 2048, v28
    v_and_b32 v29, 2047, v28
    ds_read_b32 v12, v29 offset:59136
    ds_read_b32 v13, v28 offset:58624
    ds_read_b32 v14, v28 offset:59072
    ds_read_b32 v15, v28 offset:58560
    ds_read_b32 v16, v28 offset:58112
    ds_read_b32 v17, v28 offset:57600
    ds_read_b32 v18, v28 offset:58048
    ds_read_b32 v19, v28 offset:57536
    s_waitcnt lgkmcnt(0)
    v_add_f32 v33, v33, v12
    v_add_f32 v35, v35, v13
    v_add_f32 v37, v37, v14
    v_add_f32 v39, v39, v15
    v_add_f32 v41, v41, v16
    v_add_f32 v43, v43, v17
    v_add_f32 v45, v45, v18
    v_add_f32 v47, v47, v19
L_only_119:
    s_nop 4
    s_branch L_back_116
L_y2h_81:
    s_mov_b32 s70, 262144
    s_branch L_pollc_98
L_retry_96:
    s_sub_u32 s70, s70, 1
    s_cbranch_scc1 L_polld_99
    s_mov_b64 exec, vcc
L_poll_97:
    buffer_load_dwordx2 v[10:11], v247, s[24:27], s76 offen sc1
L_pollc_98:
    s_waitcnt vmcnt(0)
    v_bitop3_b32 v11, v10, v11, s43 bitop3:0x96
    v_cmp_ne_u32 vcc, 0, v11
    s_cbranch_vccnz L_retry_96
L_polld_99:
    s_mov_b64 exec, -1
    s_cmp_lg_u32 s70, 262144
    s_cbranch_scc0 L_only_101
    s_sleep 6
L_only_101:
    s_sleep 11
    s_setprio 2
    v_mov_b32 v9, 0x3f803f80
    s_mov_b32 s70, 262144
    s_mov_b32 s75, 2456576
    buffer_load_dwordx4 v[152:155], v241, s[24:27], s75 offen sc1
    s_addk_i32 s75, 4096
    buffer_load_dwordx4 v[156:159], v241, s[24:27], s75 offen sc1
    s_addk_i32 s75, 4096
    buffer_load_dwordx4 v[160:163], v241, s[24:27], s75 offen sc1
    s_addk_i32 s75, 4096
    buffer_load_dwordx4 v[164:167], v241, s[24:27], s75 offen sc1
    s_addk_i32 s75, 4096
    buffer_load_dwordx4 v[168:171], v241, s[24:27], s75 offen sc1
    s_addk_i32 s75, 4096
    buffer_load_dwordx4 v[172:175], v241, s[24:27], s75 offen sc1
    s_addk_i32 s75, 4096
    buffer_load_dwordx4 v[176:179], v241, s[24:27], s75 offen sc1
    v_mfma_f32_16x16x16_bf16 v[184:187], v[216:217], v[80:81], 0
    v_mfma_f32_16x16x16_bf16 v[188:191], v[216:217], v[82:83], 0
    v_mfma_f32_16x16x16_bf16 v[192:195], v[218:219], v[80:81], 0
    v_mfma_f32_16x16x16_bf16 v[196:199], v[218:219], v[82:83], 0
    s_nop 4
    v_pk_mul_f32 v[208:209], v[184:185], v[88:89]
    v_pk_mul_f32 v[212:213], v[188:189], v[88:89]
    v_pk_mul_f32 v[210:211], v[186:187], v[90:91]
    v_pk_mul_f32 v[214:215], v[190:191], v[90:91]
    v_pk_fma_f32 v[208:209], v[188:189], v[92:93], v[208:209]
    v_pk_fma_f32 v[212:213], v[184:185], v[92:93], v[212:213] neg_lo:[1,0,0] neg_hi:[1,0,0]
    v_pk_fma_f32 v[210:211], v[190:191], v[94:95], v[210:211]
    v_pk_fma_f32 v[214:215], v[186:187], v[94:95], v[214:215] neg_lo:[1,0,0] neg_hi:[1,0,0]
    v_cvt_pk_bf16_f32 v200, v208, v209
    v_cvt_pk_bf16_f32 v201, v210, v211
    v_cvt_pk_bf16_f32 v202, v212, v213
    v_cvt_pk_bf16_f32 v203, v214, v215
    s_nop 1
    v_mfma_f32_16x16x32_bf16 v[144:147], v[64:67], v[200:203], 0
    v_mfma_f32_16x16x32_bf16 v[148:151], v[72:75], v[200:203], 0
    v_pk_mul_f32 v[208:209], v[192:193], v[96:97]
    v_pk_mul_f32 v[212:213], v[196:197], v[96:97]
    v_pk_mul_f32 v[210:211], v[194:195], v[98:99]
    v_pk_mul_f32 v[214:215], v[198:199], v[98:99]
    v_pk_fma_f32 v[208:209], v[196:197], v[100:101], v[208:209]
    v_pk_fma_f32 v[212:213], v[192:193], v[100:101], v[212:213] neg_lo:[1,0,0] neg_hi:[1,0,0]
    v_pk_fma_f32 v[210:211], v[198:199], v[102:103], v[210:211]
    v_pk_fma_f32 v[214:215], v[194:195], v[102:103], v[214:215] neg_lo:[1,0,0] neg_hi:[1,0,0]
    v_cvt_pk_bf16_f32 v204, v208, v209
    v_cvt_pk_bf16_f32 v205, v210, v211
    v_cvt_pk_bf16_f32 v206, v212, v213
    v_cvt_pk_bf16_f32 v207, v214, v215
    s_nop 1
    v_mfma_f32_16x16x32_bf16 v[144:147], v[68:71], v[204:207], v[144:147]
    v_mfma_f32_16x16x32_bf16 v[148:151], v[76:79], v[204:207], v[148:151]
    s_nop 6
    v_cndmask_b32_e64 v144, v144, 0, s[58:59]
    v_pk_mul_f32 v[112:113], v[144:145], v[24:25] neg_lo:[1,0] neg_hi:[1,0]
    v_pk_mul_f32 v[114:115], v[146:147], v[24:25] neg_lo:[1,0] neg_hi:[1,0]
    v_pk_mul_f32 v[116:117], v[148:149], v[24:25] neg_lo:[1,0] neg_hi:[1,0]
    v_pk_mul_f32 v[118:119], v[150:151], v[24:25] neg_lo:[1,0] neg_hi:[1,0]
    s_branch L_pp_103
L_ppr_102:
    s_sub_u32 s70, s70, 1
    s_cbranch_scc1 L_ppd_104
    s_mov_b32 s75, 2456576
    v_max3_u32 v31, v152, v153, v154
    v_max_u32 v31, v31, v155
    v_cmp_eq_u32 vcc, -1, v31
    s_cbranch_vccz L_ps_105
    s_mov_b64 exec, vcc
    buffer_load_dwordx4 v[152:155], v241, s[24:27], s75 offen sc1
    s_mov_b64 exec, -1
L_ps_105:
    s_addk_i32 s75, 4096
    v_max3_u32 v31, v156, v157, v158
    v_max_u32 v31, v31, v159
    v_cmp_eq_u32 vcc, -1, v31
    s_cbranch_vccz L_ps_106
    s_mov_b64 exec, vcc
    buffer_load_dwordx4 v[156:159], v241, s[24:27], s75 offen sc1
    s_mov_b64 exec, -1
L_ps_106:
    s_addk_i32 s75, 4096
    v_max3_u32 v31, v160, v161, v162
    v_max_u32 v31, v31, v163
    v_cmp_eq_u32 vcc, -1, v31
    s_cbranch_vccz L_ps_107
    s_mov_b64 exec, vcc
    buffer_load_dwordx4 v[160:163], v241, s[24:27], s75 offen sc1
    s_mov_b64 exec, -1
L_ps_107:
    s_addk_i32 s75, 4096
    v_max3_u32 v31, v164, v165, v166
    v_max_u32 v31, v31, v167
    v_cmp_eq_u32 vcc, -1, v31
    s_cbranch_vccz L_ps_108
    s_mov_b64 exec, vcc
    buffer_load_dwordx4 v[164:167], v241, s[24:27], s75 offen sc1
    s_mov_b64 exec, -1
L_ps_108:
    s_addk_i32 s75, 4096
    v_max3_u32 v31, v168, v169, v170
    v_max_u32 v31, v31, v171
    v_cmp_eq_u32 vcc, -1, v31
    s_cbranch_vccz L_ps_109
    s_mov_b64 exec, vcc
    buffer_load_dwordx4 v[168:171], v241, s[24:27], s75 offen sc1
    s_mov_b64 exec, -1
L_ps_109:
    s_addk_i32 s75, 4096
    v_max3_u32 v31, v172, v173, v174
    v_max_u32 v31, v31, v175
    v_cmp_eq_u32 vcc, -1, v31
    s_cbranch_vccz L_ps_110
    s_mov_b64 exec, vcc
    buffer_load_dwordx4 v[172:175], v241, s[24:27], s75 offen sc1
    s_mov_b64 exec, -1
L_ps_110:
    s_addk_i32 s75, 4096
    v_max3_u32 v31, v176, v177, v178
    v_max_u32 v31, v31, v179
    v_cmp_eq_u32 vcc, -1, v31
    s_cbranch_vccz L_ps_111
    s_mov_b64 exec, vcc
    buffer_load_dwordx4 v[176:179], v241, s[24:27], s75 offen sc1
    s_mov_b64 exec, -1
L_ps_111:
    s_waitcnt vmcnt(0)
L_pp_103:
    s_waitcnt vmcnt(6)
    v_mfma_f32_16x16x32_bf16 v[220:223], v[84:87], v[152:155], v[104:107]
    s_waitcnt vmcnt(5)
    v_mfma_f32_16x16x32_bf16 v[220:223], v[84:87], v[156:159], v[220:223]
    s_waitcnt vmcnt(4)
    v_mfma_f32_16x16x32_bf16 v[220:223], v[84:87], v[160:163], v[220:223]
    s_waitcnt vmcnt(3)
    v_mfma_f32_16x16x32_bf16 v[220:223], v[84:87], v[164:167], v[220:223]
    s_waitcnt vmcnt(2)
    v_mfma_f32_16x16x32_bf16 v[220:223], v[84:87], v[168:171], v[220:223]
    s_waitcnt vmcnt(1)
    v_mfma_f32_16x16x32_bf16 v[220:223], v[84:87], v[172:175], v[220:223]
    s_waitcnt vmcnt(0)
    v_mfma_f32_16x16x32_bf16 v[220:223], v[84:87], v[176:179], v[220:223]
    s_nop 7
    v_cmp_u_f32 vcc, v220, v220
    v_cvt_pk_bf16_f32 v12, v220, v221
    v_cvt_pk_bf16_f32 v13, v222, v223
    s_mov_b32 exec_hi, 0
    ds_write_b64 v251, v[12:13] offset:63232
    s_mov_b32 exec_hi, -1
    s_cbranch_vccnz L_ppr_102
L_ppd_104:
    s_mov_b64 exec, 1
    ds_add_u32 v246, v248 offset:12
    s_mov_b64 exec, -1
L_m4_112:
    ds_read_b32 v24, v246 offset:12
    ds_read_b128 v[216:219], v5 offset:63232
    s_waitcnt lgkmcnt(1)
    v_cmp_gt_u32 vcc, 4, v24
    s_waitcnt lgkmcnt(0)
    v_mfma_f32_16x16x16_bf16 v[184:187], v[216:217], v[80:81], 0
    v_dot2_f32_bf16 v8, v216, v9, 0
    v_dot2_f32_bf16 v10, v216, v216, 0
    v_mfma_f32_16x16x16_bf16 v[188:191], v[216:217], v[82:83], 0
    v_dot2_f32_bf16 v8, v217, v9, v8
    v_dot2_f32_bf16 v10, v217, v217, v10
    v_mfma_f32_16x16x16_bf16 v[192:195], v[218:219], v[80:81], 0
    v_dot2_f32_bf16 v8, v218, v9, v8
    v_dot2_f32_bf16 v10, v218, v218, v10
    v_mfma_f32_16x16x16_bf16 v[196:199], v[218:219], v[82:83], 0
    v_dot2_f32_bf16 v8, v219, v9, v8
    v_dot2_f32_bf16 v10, v219, v219, v10
    s_cbranch_vccnz L_m4_112
    s_cmp_eq_u32 s73, s2
    s_cbranch_scc1 L_rare_113
L_back_114:
    v_permlane32_swap_b32 v8, v10
    v_add_f32 v8, v8, v10
    v_pk_mul_f32 v[208:209], v[184:185], v[88:89]
    v_pk_mul_f32 v[212:213], v[188:189], v[88:89]
    v_add_f32_dpp v8, v8, v8 row_ror:8 row_mask:0xf bank_mask:0xf
    v_pk_mul_f32 v[210:211], v[186:187], v[90:91]
    v_pk_mul_f32 v[214:215], v[190:191], v[90:91]
    v_add_f32_dpp v8, v8, v8 row_ror:4 row_mask:0xf bank_mask:0xf
    v_pk_fma_f32 v[208:209], v[188:189], v[92:93], v[208:209]
    v_pk_fma_f32 v[212:213], v[184:185], v[92:93], v[212:213] neg_lo:[1,0,0] neg_hi:[1,0,0]
    v_add_f32_dpp v8, v8, v8 row_ror:2 row_mask:0xf bank_mask:0xf
    v_pk_fma_f32 v[210:211], v[190:191], v[94:95], v[210:211]
    v_pk_fma_f32 v[214:215], v[186:187], v[94:95], v[214:215] neg_lo:[1,0,0] neg_hi:[1,0,0]
    v_add_f32_dpp v8, v8, v8 row_ror:1 row_mask:0xf bank_mask:0xf
    v_cvt_pk_bf16_f32 v200, v208, v209
    v_cvt_pk_bf16_f32 v201, v210, v211
    v_add_f32_dpp v8, v8, v8 row_bcast:15 row_mask:0xa bank_mask:0xf
    v_cvt_pk_bf16_f32 v202, v212, v213
    v_cvt_pk_bf16_f32 v203, v214, v215
    v_mul_f32 v8, 0x3b000000, v8
    s_nop 0
    v_mfma_f32_16x16x32_bf16 v[144:147], v[64:67], v[200:203], 0
    v_mfma_f32_16x16x32_bf16 v[148:151], v[72:75], v[200:203], 0
    v_pk_mul_f32 v[208:209], v[192:193], v[96:97]
    v_pk_mul_f32 v[212:213], v[196:197], v[96:97]
    v_readlane_b32 s64, v8, 16
    v_pk_mul_f32 v[210:211], v[194:195], v[98:99]
    v_pk_mul_f32 v[214:215], v[198:199], v[98:99]
    v_readlane_b32 s65, v8, 48
    v_pk_fma_f32 v[208:209], v[196:197], v[100:101], v[208:209]
    v_pk_fma_f32 v[212:213], v[192:193], v[100:101], v[212:213] neg_lo:[1,0,0] neg_hi:[1,0,0]
    v_pk_fma_f32 v[210:211], v[198:199], v[102:103], v[210:211]
    v_pk_fma_f32 v[214:215], v[194:195], v[102:103], v[214:215] neg_lo:[1,0,0] neg_hi:[1,0,0]
    v_cvt_pk_bf16_f32 v204, v208, v209
    v_cvt_pk_bf16_f32 v205, v210, v211
    v_cvt_pk_bf16_f32 v206, v212, v213
    v_cvt_pk_bf16_f32 v207, v214, v215
    s_nop 1
    v_mfma_f32_16x16x32_bf16 v[144:147], v[68:71], v[204:207], v[144:147]
    v_mfma_f32_16x16x32_bf16 v[148:151], v[76:79], v[204:207], v[148:151]
    v_mov_b32 v8, s64
    v_fma_f32 v8, -v8, v8, s65
    v_max_f32 v8, 0, v8
    v_add_f32 v8, 0x3727c5ac, v8
    v_rsq_f32 v8, v8
    v_mov_b32 v10, 1.0
    s_nop 0
    v_cndmask_b32_e64 v144, v144, 0, s[58:59]
    v_pk_fma_f32 v[144:145], v[144:145], v[8:9], v[112:113] op_sel_hi:[1,0,1]
    v_pk_fma_f32 v[146:147], v[146:147], v[8:9], v[114:115] op_sel_hi:[1,0,1]
    ds_write_b128 v229, v[144:147] offset:0
    v_pk_fma_f32 v[148:149], v[148:149], v[8:9], v[116:117] op_sel_hi:[1,0,1]
    v_pk_fma_f32 v[150:151], v[150:151], v[8:9], v[118:119] op_sel_hi:[1,0,1]
    ds_write_b128 v229, v[148:151] offset:1024
    v_pk_fma_f32 v[34:35], v[144:145], v[10:11], v[34:35] op_sel:[1,0,0] op_sel_hi:[1,0,1]
    v_pk_fma_f32 v[36:37], v[146:147], v[10:11], v[36:37] op_sel:[0,0,0] op_sel_hi:[0,0,1]
    v_pk_fma_f32 v[38:39], v[146:147], v[10:11], v[38:39] op_sel:[1,0,0] op_sel_hi:[1,0,1]
    v_pk_fma_f32 v[40:41], v[148:149], v[10:11], v[40:41] op_sel:[0,0,0] op_sel_hi:[0,0,1]
    v_pk_fma_f32 v[42:43], v[148:149], v[10:11], v[42:43] op_sel:[1,0,0] op_sel_hi:[1,0,1]
    v_pk_fma_f32 v[44:45], v[150:151], v[10:11], v[44:45] op_sel:[0,0,0] op_sel_hi:[0,0,1]
    v_pk_fma_f32 v[46:47], v[150:151], v[10:11], v[46:47] op_sel:[1,0,0] op_sel_hi:[1,0,1]
    v_pk_fma_f32 v[32:33], v[144:145], v[10:11], v[32:33] op_sel:[0,0,0] op_sel_hi:[0,0,1]
    s_cmp_eq_u32 s73, s2
    s_cbranch_scc1 L_rare_115
L_back_116:
    s_waitcnt lgkmcnt(0)
    s_barrier
    ds_read_b32 v17, v230 offset:33088
    ds_read_b32 v19, v233
    ds_read_b32 v16, v230 offset:33024
    ds_read_b32 v18, v232
    s_setprio 3
    s_waitcnt lgkmcnt(3)
    v_fma_mix_f32 v36, v17, s74, v36 op_sel:[0,0,0] op_sel_hi:[1,0,0]
    v_fma_mix_f32 v37, v17, s74, v37 op_sel:[0,0,0] op_sel_hi:[1,0,0]
    v_fma_mix_f32 v38, v17, s74, v38 op_sel:[1,0,0] op_sel_hi:[1,0,0]
    v_fma_mix_f32 v39, v17, s74, v39 op_sel:[1,0,0] op_sel_hi:[1,0,0]
    s_waitcnt lgkmcnt(2)
    v_fma_mix_f32 v44, v19, s74, v44 op_sel:[1,0,0] op_sel_hi:[1,0,0]
    v_fma_mix_f32 v45, v19, s74, v45 op_sel:[1,0,0] op_sel_hi:[1,0,0]
    v_fma_mix_f32 v46, v19, s74, v46 op_sel:[0,0,0] op_sel_hi:[1,0,0]
    v_fma_mix_f32 v47, v19, s74, v47 op_sel:[0,0,0] op_sel_hi:[1,0,0]
    s_waitcnt lgkmcnt(1)
    v_and_b32 v16, v244, v16
    v_fma_mix_f32 v32, v16, s74, v32 op_sel:[0,0,0] op_sel_hi:[1,0,0]
    v_fma_mix_f32 v33, v16, s74, v33 op_sel:[0,0,0] op_sel_hi:[1,0,0]
    v_fma_mix_f32 v34, v16, s74, v34 op_sel:[1,0,0] op_sel_hi:[1,0,0]
    v_fma_mix_f32 v35, v16, s74, v35 op_sel:[1,0,0] op_sel_hi:[1,0,0]
    s_waitcnt lgkmcnt(0)
    v_alignbit_b32 v18, v18, v18, v245
    v_fma_mix_f32 v40, v18, s74, v40 op_sel:[1,0,0] op_sel_hi:[1,0,0]
    v_fma_mix_f32 v41, v18, s74, v41 op_sel:[1,0,0] op_sel_hi:[1,0,0]
    v_fma_mix_f32 v42, v18, s74, v42 op_sel:[0,0,0] op_sel_hi:[1,0,0]
    v_fma_mix_f32 v43, v18, s74, v43 op_sel:[0,0,0] op_sel_hi:[1,0,0]
L_yj_82:
    s_setprio 2
    v_pk_mul_f32 v[10:11], v[36:37], v[36:37]
    v_pk_mul_f32 v[12:13], v[36:37], v[52:53]
    v_pk_add_f32 v[8:9], v[36:37], v[38:39]
    v_pk_fma_f32 v[10:11], v[38:39], v[38:39], v[10:11]
    v_pk_fma_f32 v[12:13], v[38:39], v[54:55], v[12:13]
    v_pk_add_f32 v[8:9], v[8:9], v[44:45]
    v_pk_fma_f32 v[10:11], v[44:45], v[44:45], v[10:11]
    v_pk_fma_f32 v[12:13], v[44:45], v[60:61], v[12:13]
    v_pk_add_f32 v[8:9], v[8:9], v[46:47]
    v_pk_fma_f32 v[10:11], v[46:47], v[46:47], v[10:11]
    v_pk_fma_f32 v[12:13], v[46:47], v[62:63], v[12:13]
    v_pk_add_f32 v[8:9], v[8:9], v[32:33]
    v_pk_fma_f32 v[10:11], v[32:33], v[32:33], v[10:11]
    v_pk_fma_f32 v[12:13], v[32:33], v[48:49], v[12:13]
    v_pk_add_f32 v[8:9], v[8:9], v[34:35]
    v_pk_fma_f32 v[10:11], v[34:35], v[34:35], v[10:11]
    v_pk_fma_f32 v[12:13], v[34:35], v[50:51], v[12:13]
    v_pk_add_f32 v[8:9], v[8:9], v[40:41]
    v_pk_fma_f32 v[10:11], v[40:41], v[40:41], v[10:11]
    v_pk_fma_f32 v[12:13], v[40:41], v[56:57], v[12:13]
    v_pk_add_f32 v[8:9], v[8:9], v[42:43]
    v_pk_fma_f32 v[10:11], v[42:43], v[42:43], v[10:11]
    v_pk_fma_f32 v[12:13], v[42:43], v[58:59], v[12:13]
    s_setprio 1
    v_permlane32_swap_b32 v8, v9
    v_permlane32_swap_b32 v10, v11
    v_permlane32_swap_b32 v12, v13
    v_add_f32 v8, v8, v9
    v_add_f32 v10, v10, v11
    v_add_f32 v12, v12, v13
    s_nop 0
    v_permlane16_swap_b32 v8, v10
    v_add_f32 v10, v8, v10
    v_add_f32_dpp v12, v12, v12 row_ror:8 row_mask:0xf bank_mask:0xf
    s_nop 0
    v_add_f32_dpp v10, v10, v10 row_ror:8 row_mask:0xf bank_mask:0xf
    v_add_f32_dpp v12, v12, v12 row_ror:4 row_mask:0xf bank_mask:0xf
    s_nop 0
    v_add_f32_dpp v10, v10, v10 row_ror:4 row_mask:0xf bank_mask:0xf
    v_add_f32_dpp v12, v12, v12 row_ror:2 row_mask:0xf bank_mask:0xf
    s_nop 0
    v_add_f32_dpp v10, v10, v10 row_ror:2 row_mask:0xf bank_mask:0xf
    v_add_f32_dpp v12, v12, v12 row_ror:1 row_mask:0xf bank_mask:0xf
    s_nop 0
    v_add_f32_dpp v10, v10, v10 row_ror:1 row_mask:0xf bank_mask:0xf
    v_add_f32_dpp v12, v12, v12 row_bcast:15 row_mask:0xa bank_mask:0xf
    v_mul_f32 v10, 0x3b000000, v10
    s_nop 1
    v_mov_b32_dpp v8, v10 row_bcast:15 row_mask:0xa bank_mask:0xf
    v_fma_f32 v10, -v8, v8, v10
    v_max_f32 v10, 0, v10
    v_add_f32 v11, 0x3727c5ac, v10
    v_rsq_f32 v9, v11
    s_nop 0
    v_mul_f32 v138, v12, v9
    v_ashrrev_i32 v13, 31, v138
    v_bitop3_b32 v13, v13, v138, s28 bitop3:0x36
    v_and_or_b32 v12, v13, s29, v243
    s_mov_b64 exec, s[44:45]
    ds_max_u32 v246, v12 offset:4
    s_mov_b32 exec_hi, 0
    ds_add_rtn_u32 v13, v246, v248 offset:28
    ds_read_b32 v18, v246 offset:4
    s_waitcnt lgkmcnt(1)
    v_cmp_eq_u32 vcc, 7, v13
    s_waitcnt lgkmcnt(0)
    v_xor_b32 v19, 0x5a17c3e9, v18
    s_cbranch_vccz L_nokey_121
    buffer_store_dwordx2 v[18:19], v247, s[24:27], s36 offen sc1
L_nokey_121:
    s_mov_b64 exec, -1
    s_setprio 0
    s_barrier
    ds_read_b32 v14, v246 offset:4
    v_mul_f32 v17, v8, v9
    v_readlane_b32 s52, v9, 16
    v_readlane_b32 s53, v9, 48
    v_readlane_b32 s54, v17, 16
    v_readlane_b32 s55, v17, 48
    v_mov_b32 v139, v12
    s_waitcnt lgkmcnt(0)
    v_cmp_eq_u32 vcc, v14, v12
    v_mov_b32 v20, s54
    v_mov_b32 v21, s55
    s_and_b64 s[50:51], vcc, s[44:45]
    s_cselect_b32 s64, 1, 0
    s_cbranch_scc0 L_noz_122
    s_setprio 3
    s_cmp_eq_u32 s50, 0
    s_cbranch_scc1 L_zb_123
    v_fma_f32 v144, v32, s52, -v20
    v_fma_f32 v145, v34, s52, -v20
    v_cvt_pk_bf16_f32 v152, v144, v145
    ds_write_b16 v226, v152 offset:0
    ds_write_b16_d16_hi v226, v152 offset:256
    v_fma_f32 v146, v36, s52, -v20
    v_fma_f32 v147, v38, s52, -v20
    v_cvt_pk_bf16_f32 v153, v146, v147
    ds_write_b16 v226, v153 offset:32
    ds_write_b16_d16_hi v226, v153 offset:288
    v_fma_f32 v148, v40, s52, -v20
    v_fma_f32 v149, v42, s52, -v20
    v_cvt_pk_bf16_f32 v154, v148, v149
    ds_write_b16 v226, v154 offset:512
    ds_write_b16_d16_hi v226, v154 offset:768
    v_fma_f32 v150, v44, s52, -v20
    v_fma_f32 v151, v46, s52, -v20
    v_cvt_pk_bf16_f32 v155, v150, v151
    ds_write_b16 v226, v155 offset:544
    ds_write_b16_d16_hi v226, v155 offset:800
L_zj_124:
    ds_read_b128 v[168:171], v229
    v_mul_f32 v138, 0xbfb8aa3b, v138
    v_exp_f32 v138, v138
    v_fma_f32 v136, v11, v9, 1.0
    v_add_f32 v137, v225, v8
    s_mov_b32 exec_hi, 0
    v_add_f32 v137, v224, v8
    s_mov_b32 exec_hi, -1
    v_add_f32 v138, 1.0, v138
    v_rcp_f32 v138, v138
    s_waitcnt lgkmcnt(0)
    buffer_store_dwordx4 v[168:171], v5, s[24:27], s37 offen sc1
    s_mov_b64 exec, s[50:51]
    buffer_store_dwordx4 v[136:139], v247, s[24:27], s37 offen offset:1024 sc1
    s_mov_b64 exec, -1
    s_setprio 0
    s_branch L_zd_125
L_zb_123:
    v_fma_f32 v144, v33, s53, -v21
    v_fma_f32 v145, v35, s53, -v21
    v_cvt_pk_bf16_f32 v152, v144, v145
    ds_write_b16 v228, v152
    ds_write_b16_d16_hi v227, v152 offset:544
    v_fma_f32 v146, v37, s53, -v21
    v_fma_f32 v147, v39, s53, -v21
    v_cvt_pk_bf16_f32 v153, v146, v147
    ds_write_b16 v227, v153 offset:768
    ds_write_b16_d16_hi v227, v153 offset:512
    v_fma_f32 v148, v41, s53, -v21
    v_fma_f32 v149, v43, s53, -v21
    v_cvt_pk_bf16_f32 v154, v148, v149
    ds_write_b16 v227, v154 offset:288
    ds_write_b16_d16_hi v227, v154 offset:32
    v_fma_f32 v150, v45, s53, -v21
    v_fma_f32 v151, v47, s53, -v21
    v_cvt_pk_bf16_f32 v155, v150, v151
    ds_write_b16 v227, v155 offset:256
    ds_write_b16_d16_hi v227, v155 offset:0
    s_branch L_zj_124
L_noz_122:
    v_fma_f32 v136, v11, v9, 1.0
    v_add_f32 v137, v225, v8
    s_mov_b32 exec_hi, 0
    v_add_f32 v137, v224, v8
    s_mov_b32 exec_hi, -1
L_zd_125:
    v_pk_add_f32 v[224:225], v[224:225], s[54:55] neg_lo:[0,1] neg_hi:[0,1]
    v_add_f32_e64 v8, 1.0, s52
    v_add_f32_e64 v9, 1.0, s53
    v_pk_fma_f32 v[32:33], v[32:33], v[8:9], v[224:225]
    v_pk_fma_f32 v[34:35], v[34:35], v[8:9], v[224:225]
    v_pk_fma_f32 v[36:37], v[36:37], v[8:9], v[224:225]
    v_pk_fma_f32 v[38:39], v[38:39], v[8:9], v[224:225]
    v_pk_fma_f32 v[40:41], v[40:41], v[8:9], v[224:225]
    v_pk_fma_f32 v[42:43], v[42:43], v[8:9], v[224:225]
    v_pk_fma_f32 v[44:45], v[44:45], v[8:9], v[224:225]
    v_pk_fma_f32 v[46:47], v[46:47], v[8:9], v[224:225]
    v_cvt_pk_bf16_f32 v160, v32, v33
    v_cvt_pk_bf16_f32 v161, v34, v35
    v_cvt_pk_bf16_f32 v162, v36, v37
    v_cvt_pk_bf16_f32 v163, v38, v39
    v_cvt_pk_bf16_f32 v164, v40, v41
    v_cvt_pk_bf16_f32 v165, v42, v43
    v_cvt_pk_bf16_f32 v166, v44, v45
    v_cvt_pk_bf16_f32 v167, v46, v47
    ds_write_b16 v226, v160 offset:0
    ds_write_b16 v226, v161 offset:256
    ds_write_b16 v226, v162 offset:32
    ds_write_b16 v226, v163 offset:288
    ds_write_b16 v226, v164 offset:512
    ds_write_b16 v226, v165 offset:768
    ds_write_b16 v226, v166 offset:544
    ds_write_b16 v226, v167 offset:800
    ds_write_b16_d16_hi v228, v160 offset:1024
    ds_write_b16_d16_hi v227, v161 offset:1568
    ds_write_b16_d16_hi v227, v162 offset:1792
    ds_write_b16_d16_hi v227, v163 offset:1536
    ds_write_b16_d16_hi v227, v164 offset:1312
    ds_write_b16_d16_hi v227, v165 offset:1056
    ds_write_b16_d16_hi v227, v166 offset:1280
    ds_write_b16_d16_hi v227, v167 offset:1024
    ds_read_b128 v[184:187], v229
    ds_read_b128 v[188:191], v229 offset:1024
    v_readfirstlane_b32 s42, v14
    s_lshl_b32 s66, s40, 10
    s_lshl_b32 s67, s41, 10
    s_andn2_b32 s42, 2047, s42
    s_sleep 23
    s_waitcnt lgkmcnt(0)
    s_mov_b32 s72, 4096
    s_cmp_eq_u32 s40, s42
    s_cbranch_scc1 L_cand_127
    s_cmp_eq_u32 s41, s42
    s_cbranch_scc0 L_sto_128
L_cand_127:
    s_mov_b32 s76, 2114560
    v_mov_b32 v11, 1024
    v_mul_u32_u24 v8, 32, v1
    v_add_u32 v9, 2048, v8
    v_mov_b32 v10, 4096
    v_add_u32 v22, 148224, v5
    s_mov_b32 s70, 262144
    s_branch L_kl_130
L_kr_129:
    s_sub_u32 s70, s70, 1
    s_cbranch_scc1 L_kd_131
    s_mov_b64 exec, vcc
L_kl_130:
    buffer_load_dwordx2 v[16:17], v8, s[24:27], s76 offen sc1
    buffer_load_dwordx2 v[18:19], v9, s[24:27], s76 offen sc1
    buffer_load_dwordx2 v[20:21], v10, s[24:27], s76 offen sc1
    s_mov_b64 exec, -1
    s_waitcnt vmcnt(0)
    v_max3_u32 v31, v16, v18, v20
    v_bitop3_b32 v12, v16, v17, s43 bitop3:0x96
    v_bitop3_b32 v13, v18, v19, s43 bitop3:0x96
    v_max_u32_dpp v31, v31, v31 row_ror:8 row_mask:0xf bank_mask:0xf
    v_bitop3_b32 v14, v20, v21, s43 bitop3:0x96
    v_or3_b32 v12, v12, v13, v14
    v_max_u32_dpp v31, v31, v31 row_ror:4 row_mask:0xf bank_mask:0xf
    v_cmp_ne_u32 vcc, 0, v12
    s_nop 0
    v_max_u32_dpp v31, v31, v31 row_ror:2 row_mask:0xf bank_mask:0xf
    s_nop 1
    v_max_u32_dpp v31, v31, v31 row_ror:1 row_mask:0xf bank_mask:0xf
    s_nop 1
    v_max_u32_dpp v31, v31, v31 row_bcast:15 row_mask:0xa bank_mask:0xf
    s_cbranch_vccnz L_kr_129
    s_nop 0
    v_max_u32_dpp v31, v31, v31 row_bcast:31 row_mask:0xc bank_mask:0xf
L_kd_131:
    s_nop 0
    v_readlane_b32 s71, v31, 63
    s_andn2_b32 s72, 2047, s71
L_sto_128:
    s_cmp_lg_u32 s40, s72
    s_cbranch_scc0 L_only_132
    buffer_store_dwordx4 v[184:187], v5, s[32:35], s66 offen sc0 sc1
L_only_132:
    s_cmp_lg_u32 s41, s72
    s_cbranch_scc0 L_only_133
    s_cmp_lt_u32 s41, 2048
    s_cbranch_scc0 L_only_134
    buffer_store_dwordx4 v[188:191], v5, s[32:35], s67 offen sc0 sc1
L_only_134:
L_only_133:
    s_cmp_eq_u32 s72, 4096
    s_cbranch_scc1 L_fin_126
    s_cmp_lt_u32 s2, 28
    s_cbranch_scc0 L_only_135
    s_lshl_b32 s75, s2, 7
    s_add_u32 s75, s75, 2131968
    s_mov_b64 exec, 1
    buffer_store_dwordx4 v[140:143], v247, s[24:27], s75 offen sc1
    s_mov_b64 exec, -1
L_only_135:
    s_mul_i32 s75, s2, 32
    s_add_u32 s75, s75, 2097152
    s_mov_b64 exec, 1
    buffer_store_dwordx2 v[140:141], v5, s[24:27], s75 offen sc1
    s_mov_b64 exec, -1
L_fin_126:
    s_endpgm
L_F2:
    s_mov_b64 s[24:25], s[6:7]
    s_mov_b32 s26, 33554432
    s_mov_b32 s27, 0x20000
    v_and_b32 v2, 15, v0
    v_lshrrev_b32 v3, 4, v1
    v_mul_u32_u24 v11, 144, v8
    v_lshl_add_u32 v11, v9, 4, v11
    v_and_b32 v12, 32, v8
    v_add_u32 v11, v11, v12
    v_add_u32 v12, 74112, v11
    s_mul_i32 s64, s3, 1056
    v_add_u32 v18, s64, v5
    v_bfe_u32 v13, v2, 2, 1
    v_lshl_add_u32 v13, v3, 2, v13
    v_and_b32 v14, 8, v2
    v_lshl_add_u32 v13, v14, 2, v13
    v_mul_u32_u24 v16, 144, v13
    v_lshl_add_u32 v16, v14, 2, v16
    v_mul_u32_u24 v19, 1056, v13
    v_lshl_add_u32 v19, v14, 3, v19
    v_and_b32 v14, 1, v2
    v_bfe_u32 v15, v2, 1, 1
    v_lshl_add_u32 v16, v14, 3, v16
    v_mul_u32_u24 v15, 74112, v15
    s_lshl_b32 s64, s3, 4
    v_add3_u32 v16, v16, v15, s64
    v_add_u32 v17, 36992, v16
    v_and_b32 v15, 3, v2
    v_lshl_add_u32 v19, v15, 3, v19
    s_lshl_b32 s64, s3, 5
    v_add_u32 v19, s64, v19
    v_and_b32 v224, 3, v2
    v_lshlrev_b32 v224, 6, v224
    v_lshl_add_u32 v224, v3, 4, v224
    v_mov_b32 v239, 148224
    v_add_u32 v224, 148224, v224
    s_lshl_b32 s64, s3, 4
    s_add_u32 s64, s64, 149376
    v_lshl_add_u32 v225, v1, 1, s64
    v_lshlrev_b32 v226, 4, v3
    v_lshl_add_u32 v226, v14, 6, v226
    v_add_u32 v226, 149376, v226
    v_mul_u32_u24 v236, 0xaaaa, v14
    v_add_u32 v236, 0x4444, v236
    s_lshl_b32 s64, s40, 10
    s_lshl_b32 s65, s3, 7
    s_add_u32 s64, s64, s65
    v_lshl_add_u32 v227, v1, 3, s64
    v_mov_b32 v232, 0
    v_lshrrev_b32 v20, 3, v2
    v_lshl_add_u32 v20, v20, 2, v3
    v_and_b32 v21, 7, v2
    v_lshlrev_b32 v233, 10, v20
    v_lshl_add_u32 v233, v21, 4, v233
    s_mov_b32 s50, 0xff00ff00
    s_mov_b32 s51, 0xff00ff00
    v_mov_b32 v22, 33554432
    v_cndmask_b32_e64 v234, v233, v22, s[50:51]
    v_and_b32 v22, 1, v3
    v_lshl_add_u32 v21, v21, 1, v22
    s_lshl_b32 s64, s40, 4
    v_add_lshl_u32 v235, v21, s64, 1
    v_lshrrev_b32 v20, 1, v2
    v_lshlrev_b32 v21, 4, v14
    v_mov_b32 v22, 0x3f80
    v_lshlrev_b32 v21, v21, v22
    v_cmp_eq_u32 s[50:51], 0, v20
    s_nop 1
    v_cndmask_b32_e64 v228, 0, v21, s[50:51]
    v_cmp_eq_u32 s[50:51], 1, v20
    s_nop 1
    v_cndmask_b32_e64 v229, 0, v21, s[50:51]
    v_cmp_eq_u32 s[50:51], 2, v20
    s_nop 1
    v_cndmask_b32_e64 v230, 0, v21, s[50:51]
    v_cmp_eq_u32 s[50:51], 3, v20
    s_nop 1
    v_cndmask_b32_e64 v231, 0, v21, s[50:51]
    s_barrier
    buffer_load_dwordx4 v[32:35], v10, s[28:31], s75 offen
    buffer_load_dwordx4 v[64:67], v10, s[32:35], s75 offen
    s_add_u32 s75, s75, 229376
    buffer_load_dwordx4 v[36:39], v10, s[28:31], s75 offen
    buffer_load_dwordx4 v[68:71], v10, s[32:35], s75 offen
    s_add_u32 s75, s75, 229376
    s_waitcnt vmcnt(11)
    ds_write_b128 v18, v[96:99] offset:0
    s_waitcnt vmcnt(10)
    ds_write_b128 v18, v[100:103] offset:8448
    s_waitcnt vmcnt(9)
    ds_write_b128 v18, v[104:107] offset:16896
    s_waitcnt vmcnt(8)
    ds_write_b128 v18, v[108:111] offset:25344
    s_waitcnt vmcnt(7)
    ds_write_b128 v18, v[112:115] offset:33856
    s_waitcnt vmcnt(6)
    ds_write_b128 v18, v[116:119] offset:42304
    s_waitcnt vmcnt(5)
    ds_write_b128 v18, v[120:123] offset:50752
    s_waitcnt vmcnt(4)
    ds_write_b128 v18, v[124:127] offset:59200
    s_waitcnt lgkmcnt(0)
    s_barrier
    buffer_load_dwordx4 v[40:43], v10, s[28:31], s75 offen
    buffer_load_dwordx4 v[72:75], v10, s[32:35], s75 offen
    s_add_u32 s75, s75, 229376
    buffer_load_dwordx4 v[44:47], v10, s[28:31], s75 offen
    buffer_load_dwordx4 v[76:79], v10, s[32:35], s75 offen
    s_add_u32 s75, s75, 229376
    ds_read_b64_tr_b16 v[192:193], v19 offset:0
    ds_read_b64_tr_b16 v[194:195], v19 offset:2112
    ds_read_b64_tr_b16 v[196:197], v19 offset:16896
    ds_read_b64_tr_b16 v[198:199], v19 offset:19008
    ds_read_b64_tr_b16 v[200:201], v19 offset:256
    ds_read_b64_tr_b16 v[202:203], v19 offset:2368
    ds_read_b64_tr_b16 v[204:205], v19 offset:17152
    ds_read_b64_tr_b16 v[206:207], v19 offset:19264
    ds_read_b64_tr_b16 v[208:209], v19 offset:512
    ds_read_b64_tr_b16 v[210:211], v19 offset:2624
    ds_read_b64_tr_b16 v[212:213], v19 offset:17408
    ds_read_b64_tr_b16 v[214:215], v19 offset:19520
    ds_read_b64_tr_b16 v[216:217], v19 offset:768
    ds_read_b64_tr_b16 v[218:219], v19 offset:2880
    ds_read_b64_tr_b16 v[220:221], v19 offset:17664
    ds_read_b64_tr_b16 v[222:223], v19 offset:19776
    s_waitcnt lgkmcnt(0)
    s_barrier
    buffer_load_dwordx4 v[48:51], v10, s[28:31], s75 offen
    buffer_load_dwordx4 v[80:83], v10, s[32:35], s75 offen
    s_add_u32 s75, s75, 229376
    buffer_load_dwordx4 v[52:55], v10, s[28:31], s75 offen
    buffer_load_dwordx4 v[84:87], v10, s[32:35], s75 offen
    s_add_u32 s75, s75, 229376
    s_waitcnt vmcnt(10)
    ds_write_b128 v11, v[32:35] offset:0
    ds_write_b128 v12, v[64:67] offset:0
    s_waitcnt vmcnt(8)
    ds_write_b128 v11, v[36:39] offset:9248
    ds_write_b128 v12, v[68:71] offset:9248
    s_waitcnt lgkmcnt(0)
    s_barrier
    ds_read_b64_tr_b16 v[128:129], v16 offset:0
    ds_read_b64_tr_b16 v[130:131], v16 offset:288
    ds_read_b64_tr_b16 v[132:133], v16 offset:2304
    ds_read_b64_tr_b16 v[134:135], v16 offset:2592
    ds_read_b64_tr_b16 v[136:137], v16 offset:9248
    ds_read_b64_tr_b16 v[138:139], v16 offset:9536
    ds_read_b64_tr_b16 v[140:141], v16 offset:11552
    ds_read_b64_tr_b16 v[142:143], v16 offset:11840
    buffer_load_dwordx4 v[56:59], v10, s[28:31], s75 offen
    buffer_load_dwordx4 v[88:91], v10, s[32:35], s75 offen
    s_add_u32 s75, s75, 229376
    buffer_load_dwordx4 v[60:63], v10, s[28:31], s75 offen
    buffer_load_dwordx4 v[92:95], v10, s[32:35], s75 offen
    s_waitcnt vmcnt(10)
    ds_write_b128 v11, v[40:43] offset:18496
    ds_write_b128 v12, v[72:75] offset:18496
    s_waitcnt vmcnt(8)
    ds_write_b128 v11, v[44:47] offset:27744
    ds_write_b128 v12, v[76:79] offset:27744
    s_waitcnt lgkmcnt(0)
    s_barrier
    ds_read_b64_tr_b16 v[144:145], v16 offset:18496
    ds_read_b64_tr_b16 v[146:147], v16 offset:18784
    ds_read_b64_tr_b16 v[148:149], v16 offset:20800
    ds_read_b64_tr_b16 v[150:151], v16 offset:21088
    ds_read_b64_tr_b16 v[152:153], v16 offset:27744
    ds_read_b64_tr_b16 v[154:155], v16 offset:28032
    ds_read_b64_tr_b16 v[156:157], v16 offset:30048
    ds_read_b64_tr_b16 v[158:159], v16 offset:30336
    s_waitcnt vmcnt(6)
    ds_write_b128 v11, v[48:51] offset:36992
    ds_write_b128 v12, v[80:83] offset:36992
    s_waitcnt vmcnt(4)
    ds_write_b128 v11, v[52:55] offset:46240
    ds_write_b128 v12, v[84:87] offset:46240
    s_waitcnt lgkmcnt(0)
    s_barrier
    ds_read_b64_tr_b16 v[160:161], v17 offset:0
    ds_read_b64_tr_b16 v[162:163], v17 offset:288
    ds_read_b64_tr_b16 v[164:165], v17 offset:2304
    ds_read_b64_tr_b16 v[166:167], v17 offset:2592
    ds_read_b64_tr_b16 v[168:169], v17 offset:9248
    ds_read_b64_tr_b16 v[170:171], v17 offset:9536
    ds_read_b64_tr_b16 v[172:173], v17 offset:11552
    ds_read_b64_tr_b16 v[174:175], v17 offset:11840
    s_waitcnt vmcnt(2)
    ds_write_b128 v11, v[56:59] offset:55488
    ds_write_b128 v12, v[88:91] offset:55488
    s_waitcnt vmcnt(0)
    ds_write_b128 v11, v[60:63] offset:64736
    ds_write_b128 v12, v[92:95] offset:64736
    s_waitcnt lgkmcnt(0)
    s_barrier
    ds_read_b64_tr_b16 v[176:177], v17 offset:18496
    ds_read_b64_tr_b16 v[178:179], v17 offset:18784
    ds_read_b64_tr_b16 v[180:181], v17 offset:20800
    ds_read_b64_tr_b16 v[182:183], v17 offset:21088
    ds_read_b64_tr_b16 v[184:185], v17 offset:27744
    ds_read_b64_tr_b16 v[186:187], v17 offset:28032
    ds_read_b64_tr_b16 v[188:189], v17 offset:30048
    ds_read_b64_tr_b16 v[190:191], v17 offset:30336
    s_mov_b64 s[32:33], s[16:17]
    s_mov_b32 s34, 2097152
    s_mov_b32 s35, 0x20000
    s_mov_b32 s77, 2097152
    s_mov_b32 s79, 2159360
    s_mov_b32 s78, 2456576
    s_lshl_b32 s80, s40, 7
    s_add_u32 s80, s80, 2131968
    s_mov_b32 s81, 0
    s_lshl_b32 s64, s40, 5
    v_lshl_add_u32 v238, v1, 8, s64
L_Floop:
    v_mov_b32 v64, 0
    v_mov_b32 v65, 0
    v_mov_b32 v66, 0
    v_mov_b32 v67, 0
    v_mov_b32 v68, 0
    v_mov_b32 v69, 0
    v_mov_b32 v70, 0
    v_mov_b32 v71, 0
    v_mov_b32 v72, 0
    v_mov_b32 v73, 0
    v_mov_b32 v74, 0
    v_mov_b32 v75, 0
    v_mov_b32 v76, 0
    v_mov_b32 v77, 0
    v_mov_b32 v78, 0
    v_mov_b32 v79, 0
    v_mov_b32 v80, 0
    v_mov_b32 v81, 0
    v_mov_b32 v82, 0
    v_mov_b32 v83, 0
    v_mov_b32 v84, 0
    v_mov_b32 v85, 0
    v_mov_b32 v86, 0
    v_mov_b32 v87, 0
    s_cmp_eq_u32 s3, 0
    s_cbranch_scc0 L_only_136
    s_mov_b32 s70, 262144
    buffer_load_dwordx2 v[10:11], v232, s[24:27], s80 offen sc1
    s_branch L_pollc_139
L_retry_137:
    s_sub_u32 s70, s70, 1
    s_cbranch_scc1 L_polld_140
    s_mov_b64 exec, vcc
L_poll_138:
    buffer_load_dwordx2 v[10:11], v232, s[24:27], s80 offen sc1
L_pollc_139:
    s_waitcnt vmcnt(0)
    v_bitop3_b32 v11, v10, v11, s43 bitop3:0x96
    v_cmp_ne_u32 vcc, 0, v11
    s_cbranch_vccnz L_retry_137
L_polld_140:
    s_mov_b64 exec, -1
    s_mov_b32 s76, s77
    v_mov_b32 v11, 1024
    v_mul_u32_u24 v8, 32, v1
    v_add_u32 v9, 2048, v8
    v_mov_b32 v10, 4096
    v_add_u32 v22, 148224, v5
    s_cmp_lg_u32 s70, 262144
    s_cbranch_scc0 L_only_145
    s_sleep 13
    s_cmp_eq_u32 s81, 0
    s_cbranch_scc0 L_only_146
    s_sleep 6
L_only_146:
L_only_145:
    s_mov_b32 s70, 262144
    s_branch L_kl_143
L_kr_142:
    s_sub_u32 s70, s70, 1
    s_cbranch_scc1 L_kd_144
    s_mov_b64 exec, vcc
L_kl_143:
    buffer_load_dwordx2 v[16:17], v8, s[24:27], s76 offen sc1
    buffer_load_dwordx2 v[18:19], v9, s[24:27], s76 offen sc1
    buffer_load_dwordx2 v[20:21], v10, s[24:27], s76 offen sc1
    s_mov_b64 exec, -1
    s_waitcnt vmcnt(0)
    v_max3_u32 v31, v16, v18, v20
    v_bitop3_b32 v12, v16, v17, s43 bitop3:0x96
    v_bitop3_b32 v13, v18, v19, s43 bitop3:0x96
    v_max_u32_dpp v31, v31, v31 row_ror:8 row_mask:0xf bank_mask:0xf
    v_bitop3_b32 v14, v20, v21, s43 bitop3:0x96
    v_or3_b32 v12, v12, v13, v14
    v_max_u32_dpp v31, v31, v31 row_ror:4 row_mask:0xf bank_mask:0xf
    v_cmp_ne_u32 vcc, 0, v12
    s_nop 0
    v_max_u32_dpp v31, v31, v31 row_ror:2 row_mask:0xf bank_mask:0xf
    s_nop 1
    v_max_u32_dpp v31, v31, v31 row_ror:1 row_mask:0xf bank_mask:0xf
    s_nop 1
    v_max_u32_dpp v31, v31, v31 row_bcast:15 row_mask:0xa bank_mask:0xf
    s_cbranch_vccnz L_kr_142
    s_nop 0
    v_max_u32_dpp v31, v31, v31 row_bcast:31 row_mask:0xc bank_mask:0xf
L_kd_144:
    s_nop 0
    v_readlane_b32 s71, v31, 63
    s_andn2_b32 s72, 2047, s71
    s_and_b32 s73, s72, 255
    s_sub_u32 s65, 256, s73
    s_min_u32 s73, s73, s65
    s_mul_i32 s76, s73, 1152
    s_add_u32 s76, s76, s79
    s_mov_b32 s70, 262144
    buffer_load_dwordx4 v[12:15], v5, s[24:27], s76 offen sc1
    buffer_load_dwordx4 v[16:19], v11, s[24:27], s76 offen sc1
    s_cmp_eq_u32 s81, 0
    s_cbranch_scc0 L_only_152
    s_lshl_b32 s69, s40, 7
    s_add_u32 s69, s69, 2139136
    v_mov_b32 v28, 1
    v_mov_b32 v29, 0x5a17c3e8
    s_mov_b64 exec, 1
    buffer_store_dwordx2 v[28:29], v5, s[24:27], s69 offen sc1
    s_mov_b64 exec, -1
    s_branch L_polle_151
L_only_152:
    s_cmp_lt_u32 s40, 8
    s_cbranch_scc0 L_only_153
    s_lshl_b32 s64, s72, 10
    s_mov_b64 exec, 0xf
    buffer_atomic_add v232, v238, s[32:35], s64 offen
    s_mov_b64 exec, -1
    s_branch L_polle_151
L_only_153:
    s_branch L_pollc_149
L_retry_147:
    s_sub_u32 s70, s70, 1
    s_cbranch_scc1 L_polld_150
    s_mov_b64 exec, vcc
L_poll_148:
    buffer_load_dwordx4 v[12:15], v5, s[24:27], s76 offen sc1
    buffer_load_dwordx4 v[16:19], v11, s[24:27], s76 offen sc1
L_pollc_149:
    s_waitcnt vmcnt(0)
L_polle_151:
    s_waitcnt vmcnt(1)
    ds_write_b128 v22, v[12:15]
    s_mov_b64 s[50:51], exec
    s_and_b64 exec, exec, 1
    ds_write_b128 v22, v[16:19] offset:1024
    s_mov_b64 exec, s[50:51]
    v_max3_u32 v31, v12, v13, v14
    v_max3_u32 v31, v31, v15, v16
    v_max3_u32 v31, v31, v17, v18
    v_max_u32 v31, v31, v19
    v_cmp_eq_u32 vcc, -1, v31
    s_cbranch_vccnz L_retry_147
L_polld_150:
    s_mov_b64 exec, -1
L_only_136:
    s_waitcnt lgkmcnt(0)
    s_barrier
    ds_read_b128 v[32:35], v224 offset:0
    ds_read_b128 v[36:39], v224 offset:256
    ds_read_b128 v[40:43], v224 offset:512
    ds_read_b128 v[44:47], v224 offset:768
    ds_read_b32 v24, v239 offset:1032
    s_waitcnt lgkmcnt(4)
    v_smfmac_f32_16x16x64_bf16 v[80:83], v[32:35], v[128:135], v236
    v_smfmac_f32_16x16x64_bf16 v[84:87], v[32:35], v[136:143], v236
    s_waitcnt lgkmcnt(3)
    v_smfmac_f32_16x16x64_bf16 v[80:83], v[36:39], v[144:151], v236
    v_smfmac_f32_16x16x64_bf16 v[84:87], v[36:39], v[152:159], v236
    s_waitcnt lgkmcnt(2)
    v_smfmac_f32_16x16x64_bf16 v[80:83], v[40:43], v[160:167], v236
    v_smfmac_f32_16x16x64_bf16 v[84:87], v[40:43], v[168:175], v236
    s_waitcnt lgkmcnt(1)
    v_smfmac_f32_16x16x64_bf16 v[80:83], v[44:47], v[176:183], v236
    v_smfmac_f32_16x16x64_bf16 v[84:87], v[44:47], v[184:191], v236
    s_waitcnt lgkmcnt(0)
    s_nop 5
    v_add_f32 v10, v80, v81
    v_add_f32 v11, v86, v87
    v_add_f32 v10, v10, v11
    v_mul_f32 v11, 0xbfb8aa3b, v10
    v_exp_f32 v11, v11
    v_mul_f32_dpp v12, v10, v10 row_ror:8 row_mask:0xf bank_mask:0xf
    v_add_f32 v11, 1.0, v11
    v_rcp_f32 v11, v11
    v_mul_f32 v12, v12, v24
    v_mul_f32 v12, v12, v11
    v_cvt_pk_bf16_f32 v12, v12, v12
    s_mov_b64 exec, 0xff
    ds_write_b16 v225, v12
    s_mov_b64 exec, -1
    s_waitcnt lgkmcnt(0)
    s_barrier
    ds_read_b128 v[12:15], v226
    s_waitcnt lgkmcnt(0)
    v_smfmac_f32_16x16x64_bf16 v[64:67], v[12:15], v[192:199], v236
    v_smfmac_f32_16x16x64_bf16 v[68:71], v[12:15], v[200:207], v236
    v_smfmac_f32_16x16x64_bf16 v[72:75], v[12:15], v[208:215], v236
    v_smfmac_f32_16x16x64_bf16 v[76:79], v[12:15], v[216:223], v236
    s_nop 4
    v_add_f32 v64, v64, v65
    v_add_f32 v68, v68, v69
    v_add_f32 v72, v72, v73
    v_add_f32 v76, v76, v77
    v_cvt_pk_bf16_f32 v20, v64, v68
    v_cvt_pk_bf16_f32 v21, v72, v76
    s_mov_b64 exec, 0xffff
    buffer_store_dwordx2 v[20:21], v227, s[24:27], s78 offen sc1
    s_mov_b64 exec, -1
    s_cmp_lg_u32 s81, 0
    s_cbranch_scc1 L_Fend
    s_mov_b32 s77, 2114560
    s_mov_b32 s79, 2307968
    s_mov_b32 s78, 2485248
    s_add_u32 s80, s80, 3584
    s_mov_b32 s81, 1
    s_branch L_Floop
L_Fend:
    s_cmp_lt_u32 s40, 8
    s_cbranch_scc0 L_only_154
    s_cmp_eq_u32 s3, 0
    s_cbranch_scc0 L_only_155
    ds_read_b128 v[16:19], v239 offset:1024
    v_add_u32 v9, 148224, v235
    ds_read_u16_d16_hi v12, v9 offset:0
    ds_read_u16_d16_hi v13, v9 offset:256
    ds_read_u16_d16_hi v14, v9 offset:512
    ds_read_u16_d16_hi v15, v9 offset:768
    s_lshl_b32 s76, s72, 10
    s_waitcnt lgkmcnt(0)
    v_fma_f32 v12, v12, v16, v17
    v_fma_f32 v13, v13, v16, v17
    v_fma_f32 v14, v14, v16, v17
    v_fma_f32 v15, v15, v16, v17
    s_waitcnt vmcnt(0)
    s_mov_b32 s70, 262145
L_fr_156:
    s_lshl_b32 s75, s40, 7
    s_add_u32 s75, s75, 2485248
    buffer_load_dwordx4 v[32:35], v233, s[24:27], s75 offen sc1
    s_addk_i32 s75, 8192
    buffer_load_dwordx4 v[36:39], v233, s[24:27], s75 offen sc1
    s_addk_i32 s75, 8192
    buffer_load_dwordx4 v[40:43], v233, s[24:27], s75 offen sc1
    s_addk_i32 s75, 8192
    buffer_load_dwordx4 v[44:47], v234, s[24:27], s75 offen sc1
    s_sub_u32 s70, s70, 1
    s_cselect_b64 s[50:51], 0, -1
    s_waitcnt vmcnt(3)
    v_mfma_f32_16x16x32_bf16 v[64:67], v[228:231], v[32:35], 0
    s_waitcnt vmcnt(2)
    v_mfma_f32_16x16x32_bf16 v[64:67], v[228:231], v[36:39], v[64:67]
    s_waitcnt vmcnt(1)
    v_mfma_f32_16x16x32_bf16 v[64:67], v[228:231], v[40:43], v[64:67]
    s_waitcnt vmcnt(0)
    v_mfma_f32_16x16x32_bf16 v[64:67], v[228:231], v[44:47], v[64:67]
    s_nop 7
    v_cmp_u_f32 vcc, v64, v64
    v_add_f32_dpp v20, v64, v12 row_ror:8 row_mask:0xf bank_mask:0xf
    v_add_f32_dpp v21, v65, v13 row_ror:8 row_mask:0xf bank_mask:0xf
    v_add_f32_dpp v22, v66, v14 row_ror:8 row_mask:0xf bank_mask:0xf
    v_add_f32_dpp v23, v67, v15 row_ror:8 row_mask:0xf bank_mask:0xf
    v_add_f32 v20, v64, v20
    v_add_f32 v21, v65, v21
    v_add_f32 v22, v66, v22
    v_add_f32 v23, v67, v23
    s_and_b64 vcc, vcc, s[50:51]
    v_cvt_pk_bf16_f32 v24, v20, v21
    v_cvt_pk_bf16_f32 v25, v22, v23
    s_cbranch_scc1 L_fr_156
    s_mov_b64 exec, 0x00ff00ff
    buffer_store_short v24, v235, s[32:35], s76 offen
    buffer_store_short_d16_hi v24, v235, s[32:35], s76 offen offset:256
    buffer_store_short v25, v235, s[32:35], s76 offen offset:512
    buffer_store_short_d16_hi v25, v235, s[32:35], s76 offen offset:768
L_only_155:
L_only_154:
L_end:
    s_endpgm
.p2align 8
.type L_table,@object
L_table:
.long 0x3c003c00,0x3c003c00,0x3c003c00,0x3c003c00,0x3c00,0xb23e3bd9,0xbc00,0x323ebbd9,0xbc003c00,0xbb643b64,0xbc003c00,0xbb643b64,0x3c00,0x38723aa7,0xbc00,0xb872baa7
.long 0x3c003c00,0x39a839a8,0x3c003c00,0x39a839a8,0x3c00,0xbaa73872,0xbc00,0x3aa7b872,0xbc003c00,0xb61f361f,0xbc003c00,0xb61f361f,0x3c00,0x3bd9323e,0xbc00,0xbbd9b23e
.long 0x3c003c00,0x0,0x3c003c00,0x0,0x3c00,0xbbd9b23e,0xbc00,0x3bd9323e,0xbc003c00,0x361fb61f,0xbc003c00,0x361fb61f,0x3c00,0x3aa7b872,0xbc00,0xbaa73872
.long 0x3c003c00,0xb9a8b9a8,0x3c003c00,0xb9a8b9a8,0x3c00,0xb872baa7,0xbc00,0x38723aa7,0xbc003c00,0x3b64bb64,0xbc003c00,0x3b64bb64,0x3c00,0x323ebbd9,0xbc00,0xb23e3bd9
.long 0x3c003c00,0x3c003c00,0x3c003c00,0x3c003c00,0xb61f3b64,0xb8723aa7,0x361fbb64,0x3872baa7,0xb9a839a8,0xb61f361f,0xb9a839a8,0xb61f361f,0x3b64361f,0x3bd9b23e,0xbb64b61f,0xbbd9323e
.long 0x0,0xb9a8b9a8,0x0,0xb9a8b9a8,0xbb64b61f,0xb23ebbd9,0x3b64361f,0x323e3bd9,0x39a8b9a8,0x3b64bb64,0x39a8b9a8,0x3b64bb64,0x361fbb64,0xbaa7b872,0xb61f3b64,0x3aa73872
.long 0xbc00bc00,0x0,0xbc00bc00,0x0,0x361fbb64,0x3aa73872,0xb61f3b64,0xbaa7b872,0x39a8b9a8,0xbb643b64,0x39a8b9a8,0xbb643b64,0xbb64b61f,0x323e3bd9,0x3b64361f,0xb23ebbd9
.long 0x0,0x39a839a8,0x0,0x39a839a8,0x3b64361f,0xbbd9323e,0xbb64b61f,0x3bd9b23e,0xb9a839a8,0x361fb61f,0xb9a839a8,0x361fb61f,0xb61f3b64,0x3872baa7,0x361fbb64,0xb8723aa7
.long 0x3c003c00,0x3c003c00,0x3c003c00,0x3c003c00,0xb9a839a8,0xbaa73872,0x39a8b9a8,0x3aa7b872,0x0,0x361fb61f,0x0,0x361fb61f,0x39a8b9a8,0x323ebbd9,0xb9a839a8,0xb23e3bd9
.long 0xbc00bc00,0xb9a8b9a8,0xbc00bc00,0xb9a8b9a8,0x39a8b9a8,0x3bd9323e,0xb9a839a8,0xbbd9b23e,0x0,0xbb643b64,0x0,0xbb643b64,0xb9a839a8,0x38723aa7,0x39a8b9a8,0xb872baa7
.long 0x3c003c00,0x0,0x3c003c00,0x0,0xb9a839a8,0xb872baa7,0x39a8b9a8,0x38723aa7,0x0,0x3b64bb64,0x0,0x3b64bb64,0x39a8b9a8,0xbbd9b23e,0xb9a839a8,0x3bd9323e
.long 0xbc00bc00,0x39a839a8,0xbc00bc00,0x39a839a8,0x39a8b9a8,0xb23e3bd9,0xb9a839a8,0x323ebbd9,0x0,0xb61f361f,0x0,0xb61f361f,0xb9a839a8,0x3aa7b872,0x39a8b9a8,0xbaa73872
.long 0x3c003c00,0x3c003c00,0x3c003c00,0x3c003c00,0xbb64361f,0xbbd9323e,0x3b64b61f,0x3bd9b23e,0x39a8b9a8,0x3b64bb64,0x39a8b9a8,0x3b64bb64,0xb61fbb64,0xbaa7b872,0x361f3b64,0x3aa73872
.long 0x0,0x39a839a8,0x0,0x39a839a8,0x361f3b64,0xb8723aa7,0xb61fbb64,0x3872baa7,0xb9a839a8,0x361fb61f,0xb9a839a8,0x361fb61f,0x3b64b61f,0xb23ebbd9,0xbb64361f,0x323e3bd9
.long 0xbc00bc00,0x0,0xbc00bc00,0x0,0x3b64b61f,0x323e3bd9,0xbb64361f,0xb23ebbd9,0xb9a839a8,0xb61f361f,0xb9a839a8,0xb61f361f,0x361f3b64,0x3872baa7,0xb61fbb64,0xb8723aa7
.long 0x0,0xb9a8b9a8,0x0,0xb9a8b9a8,0xb61fbb64,0x3aa73872,0x361f3b64,0xbaa7b872,0x39a8b9a8,0xbb643b64,0x39a8b9a8,0xbb643b64,0xbb64361f,0x3bd9b23e,0x3b64b61f,0xbbd9323e
.long 0x80008000,0x80008000,0x80008000,0x80008000,0xbc008000,0xbbd9b23e,0x3c008000,0x3bd9323e,0x80008000,0x361fb61f,0x80008000,0x361fb61f,0x3c008000,0x3aa7b872,0xbc008000,0xbaa73872
.long 0x80008000,0xb9a8b9a8,0x80008000,0xb9a8b9a8,0xbc008000,0xb872baa7,0x3c008000,0x38723aa7,0x80008000,0x3b64bb64,0x80008000,0x3b64bb64,0x3c008000,0x323ebbd9,0xbc008000,0xb23e3bd9
.long 0x80008000,0xbc00bc00,0x80008000,0xbc00bc00,0xbc008000,0x323ebbd9,0x3c008000,0xb23e3bd9,0x80008000,0x3b64bb64,0x80008000,0x3b64bb64,0x3c008000,0xb872baa7,0xbc008000,0x38723aa7
.long 0x80008000,0xb9a8b9a8,0x80008000,0xb9a8b9a8,0xbc008000,0x3aa7b872,0x3c008000,0xbaa73872,0x80008000,0x361fb61f,0x80008000,0x361fb61f,0x3c008000,0xbbd9b23e,0xbc008000,0x3bd9323e
.long 0x80008000,0x80008000,0x80008000,0x80008000,0xbb64b61f,0xbaa7b872,0x3b64361f,0x3aa73872,0x39a8b9a8,0x3b64bb64,0x39a8b9a8,0x3b64bb64,0x361fbb64,0xb23ebbd9,0xb61f3b64,0x323e3bd9
.long 0xbc00bc00,0xb9a8b9a8,0xbc00bc00,0xb9a8b9a8,0x361fbb64,0x3bd9b23e,0xb61f3b64,0xbbd9323e,0x39a8b9a8,0xb61f361f,0x39a8b9a8,0xb61f361f,0xbb64b61f,0xb8723aa7,0x3b64361f,0x3872baa7
.long 0x80008000,0x3c003c00,0x80008000,0x3c003c00,0x3b64361f,0xb8723aa7,0xbb64b61f,0x3872baa7,0xb9a839a8,0xb61f361f,0xb9a839a8,0xb61f361f,0xb61f3b64,0x3bd9b23e,0x361fbb64,0xbbd9323e
.long 0x3c003c00,0xb9a8b9a8,0x3c003c00,0xb9a8b9a8,0xb61f3b64,0xb23ebbd9,0x361fbb64,0x323e3bd9,0xb9a839a8,0x3b64bb64,0xb9a839a8,0x3b64bb64,0x3b64361f,0xbaa7b872,0xbb64b61f,0x3aa73872
.long 0x80008000,0x80008000,0x80008000,0x80008000,0xb9a8b9a8,0xb872baa7,0x39a839a8,0x38723aa7,0x3c00bc00,0x3b64bb64,0x3c00bc00,0x3b64bb64,0xb9a8b9a8,0xbbd9b23e,0x39a839a8,0x3bd9323e
.long 0x80008000,0x39a839a8,0x80008000,0x39a839a8,0x39a839a8,0xb23e3bd9,0xb9a8b9a8,0x323ebbd9,0xbc003c00,0xb61f361f,0xbc003c00,0xb61f361f,0x39a839a8,0x3aa7b872,0xb9a8b9a8,0xbaa73872
.long 0x80008000,0xbc00bc00,0x80008000,0xbc00bc00,0xb9a8b9a8,0x3aa7b872,0x39a839a8,0xbaa73872,0x3c00bc00,0xb61f361f,0x3c00bc00,0xb61f361f,0xb9a8b9a8,0xb23e3bd9,0x39a839a8,0x323ebbd9
.long 0x80008000,0x39a839a8,0x80008000,0x39a839a8,0x39a839a8,0xbbd9b23e,0xb9a8b9a8,0x3bd9323e,0xbc003c00,0x3b64bb64,0xbc003c00,0x3b64bb64,0x39a839a8,0xb872baa7,0xb9a8b9a8,0x38723aa7
.long 0x80008000,0x80008000,0x80008000,0x80008000,0xb61fbb64,0xb23ebbd9,0x361f3b64,0x323e3bd9,0x39a8b9a8,0x361fb61f,0x39a8b9a8,0x361fb61f,0xbb64361f,0xb8723aa7,0x3b64b61f,0x3872baa7
.long 0x3c003c00,0x39a839a8,0x3c003c00,0x39a839a8,0xbb64361f,0xbaa7b872,0x3b64b61f,0x3aa73872,0x39a8b9a8,0x3b64bb64,0x39a8b9a8,0x3b64bb64,0xb61fbb64,0xbbd9323e,0x361f3b64,0x3bd9b23e
.long 0x80008000,0x3c003c00,0x80008000,0x3c003c00,0x361f3b64,0xbbd9323e,0xb61fbb64,0x3bd9b23e,0xb9a839a8,0x3b64bb64,0xb9a839a8,0x3b64bb64,0x3b64b61f,0xbaa7b872,0xbb64361f,0x3aa73872
.long 0xbc00bc00,0x39a839a8,0xbc00bc00,0x39a839a8,0x3b64b61f,0xb8723aa7,0xbb64361f,0x3872baa7,0xb9a839a8,0x361fb61f,0xb9a839a8,0x361fb61f,0x361f3b64,0xb23ebbd9,0xb61fbb64,0x323e3bd9
.long 0x3c003c00,0x3c003c00,0x0,0x0,0x0,0x0,0x3c003c00,0x3c003c00,0x3c00,0xbc00,0x3c000000,0xbc000000,0xbc000000,0x3c000000,0x3c00,0xbc00
.long 0x3b643c00,0x361f39a8,0x361f0000,0x3b6439a8,0xb61f0000,0xbb64b9a8,0x3b643c00,0x361f39a8,0xb61f3c00,0x3b64b9a8,0x3b640000,0xb61fb9a8,0xbb640000,0x361f39a8,0xb61f3c00,0x3b64b9a8
.long 0x39a83c00,0xb9a80000,0x39a80000,0x39a83c00,0xb9a80000,0xb9a8bc00,0x39a83c00,0xb9a80000,0xb9a83c00,0x39a80000,0x39a80000,0x39a8bc00,0xb9a80000,0xb9a83c00,0xb9a83c00,0x39a80000
.long 0x361f3c00,0xbb64b9a8,0x3b640000,0xb61f39a8,0xbb640000,0x361fb9a8,0x361f3c00,0xbb64b9a8,0xbb643c00,0xb61f39a8,0x361f0000,0x3b64b9a8,0xb61f0000,0xbb6439a8,0xbb643c00,0xb61f39a8
.long 0x3c003c00,0x3c003c00,0x0,0x0,0x0,0x0,0x3c003c00,0x3c003c00,0x3c00,0xbc00,0x3c000000,0xbc000000,0xbc000000,0x3c000000,0x3c00,0xbc00
.long 0xb61f0000,0xbb64b9a8,0x3b643c00,0x361f39a8,0xbb64bc00,0xb61fb9a8,0xb61f0000,0xbb64b9a8,0xbb640000,0x361f39a8,0xb61f3c00,0x3b64b9a8,0x361fbc00,0xbb6439a8,0xbb640000,0x361f39a8
.long 0xb9a8bc00,0x39a80000,0xb9a80000,0xb9a8bc00,0x39a80000,0x39a83c00,0xb9a8bc00,0x39a80000,0x39a8bc00,0xb9a80000,0xb9a80000,0xb9a83c00,0x39a80000,0x39a8bc00,0x39a8bc00,0xb9a80000
.long 0x3b640000,0xb61f39a8,0xb61fbc00,0x3b6439a8,0x361f3c00,0xbb64b9a8,0x3b640000,0xb61f39a8,0x361f0000,0x3b64b9a8,0x3b64bc00,0x361fb9a8,0xbb643c00,0xb61f39a8,0x361f0000,0x3b64b9a8
.long 0x3c003c00,0x3c003c00,0x0,0x0,0x0,0x0,0x3c003c00,0x3c003c00,0x3c00,0xbc00,0x3c000000,0xbc000000,0xbc000000,0x3c000000,0x3c00,0xbc00
.long 0xbb64bc00,0xb61fb9a8,0xb61f0000,0xbb64b9a8,0x361f0000,0x3b6439a8,0xbb64bc00,0xb61fb9a8,0x361fbc00,0xbb6439a8,0xbb640000,0x361f39a8,0x3b640000,0xb61fb9a8,0x361fbc00,0xbb6439a8
.long 0x39a83c00,0xb9a80000,0x39a80000,0x39a83c00,0xb9a80000,0xb9a8bc00,0x39a83c00,0xb9a80000,0xb9a83c00,0x39a80000,0x39a80000,0x39a8bc00,0xb9a80000,0xb9a83c00,0xb9a83c00,0x39a80000
.long 0xb61fbc00,0x3b6439a8,0xbb640000,0x361fb9a8,0x3b640000,0xb61f39a8,0xb61fbc00,0x3b6439a8,0x3b64bc00,0x361fb9a8,0xb61f0000,0xbb6439a8,0x361f0000,0x3b64b9a8,0x3b64bc00,0x361fb9a8
.long 0x3c003c00,0x3c003c00,0x0,0x0,0x0,0x0,0x3c003c00,0x3c003c00,0x3c00,0xbc00,0x3c000000,0xbc000000,0xbc000000,0x3c000000,0x3c00,0xbc00
.long 0x361f0000,0x3b6439a8,0xbb64bc00,0xb61fb9a8,0x3b643c00,0x361f39a8,0x361f0000,0x3b6439a8,0x3b640000,0xb61fb9a8,0x361fbc00,0xbb6439a8,0xb61f3c00,0x3b64b9a8,0x3b640000,0xb61fb9a8
.long 0xb9a8bc00,0x39a80000,0xb9a80000,0xb9a8bc00,0x39a80000,0x39a83c00,0xb9a8bc00,0x39a80000,0x39a8bc00,0xb9a80000,0xb9a80000,0xb9a83c00,0x39a80000,0x39a8bc00,0x39a8bc00,0xb9a80000
.long 0xbb640000,0x361fb9a8,0x361f3c00,0xbb64b9a8,0xb61fbc00,0x3b6439a8,0xbb640000,0x361fb9a8,0xb61f0000,0xbb6439a8,0xbb643c00,0xb61f39a8,0x3b64bc00,0x361fb9a8,0xb61f0000,0xbb6439a8
.long 0x3c003c00,0x3c003c00,0x0,0x0,0x3c003c00,0x3bff3bff,0x22480000,0x28b62648,0x3bff3c00,0x3bfa3bfe,0x26480000,0x2cb52a48,0x3bff3c00,0x3bf43bfa,0x28b60000,0x2f0e2cb5
.long 0x3bfe3c00,0x3bea3bf6,0x2a480000,0x30b22e46,0x3bfc3c00,0x3bdd3bf1,0x2bd90000,0x31db2fd6,0x3bfa3c00,0x3bce3bea,0x2cb50000,0x330330b2,0x3bf83c00,0x3bbc3be2,0x2d7e0000,0x34143179
.long 0x3bf63c00,0x3ba83bd9,0x2e460000,0x34a5323e,0x3bf43c00,0x3b913bce,0x2f0e0000,0x35343303,0x3bf13c00,0x3b773bc3,0x2fd60000,0x35c233c6,0x3bed3c00,0x3b5a3bb6,0x304e0000,0x364e3444
.long 0x3bea3c00,0x3b3b3ba8,0x30b20000,0x36d734a5,0x3be63c00,0x3b1a3b99,0x31150000,0x375e3505,0x3be23c00,0x3af63b88,0x31790000,0x37e33564,0x3bdd3c00,0x3ad03b77,0x31db0000,0x383235c2
.long 0x3c003c00,0x3c003c00,0x0,0x0,0x3bfc3bfe,0x3bf83bfa,0x2bd92a48,0x2d7e2cb5,0x3bf13bf6,0x3be23bea,0x2fd62e46,0x317930b2,0x3bdd3bea,0x3bbc3bce,0x31db30b2,0x34143303
.long 0x3bc33bd9,0x3b883ba8,0x33c6323e,0x356434a5,0x3ba03bc3,0x3b463b77,0x34d533c6,0x36aa35c2,0x3b773ba8,0x3af63b3b,0x35c234a5,0x37e336d7,0x3b463b88,0x3a993af6,0x36aa3564,0x388737e3
.long 0x3b0e3b64,0x3a2f3aa7,0x378b361f,0x39133872,0x3ad03b3b,0x39ba3a4f,0x383236d7,0x399638ec,0x3a8a3b0e,0x393a39ed,0x389b378b,0x3a0f395f,0x3a3f3add,0x38b03984,0x3900381d,0x3a7c39cb
.long 0x39ed3aa7,0x381d3913,0x395f3872,0x3add3a2f,0x39963a6d,0x3705389b,0x39ba38c4,0x3b303a8a,0x393a3a2f,0x35c2381d,0x3a0f3913,0x3b773add,0x38d839ed,0x34753732,0x3a5e395f,0x3baf3b25
.long 0x3c003c00,0x3c003c00,0x0,0x0,0x3bf43bf6,0x3bed3bf1,0x2f0e2e46,0x304e2fd6,0x3bce3bd9,0x3bb63bc3,0x3303323e,0x344433c6,0x3b913ba8,0x3b5a3b77,0x353434a5,0x364e35c2
.long 0x3b3b3b64,0x3add3b0e,0x36d7361f,0x381d378b,0x3ad03b0e,0x3a3f3a8a,0x3832378b,0x3900389b,0x3a4f3aa7,0x398439ed,0x38ec3872,0x39cb395f,0x39ba3a2f,0x38b0393a,0x39963913,0x3a7c3a0f
.long 0x391339a8,0x378b3872,0x3a2f39a8,0x3b0e3aa7,0x385d3913,0x35933732,0x3ab53a2f,0x3b803b25,0x37323872,0x33033564,0x3b253aa7,0x3bce3b88,0x3593378b,0x2d7e3303,0x3b803b0e,0x3bf83bce
.long 0x33c6361f,0xaa482e46,0x3bc33b64,0x3bfe3bf6,0x304e34a5,0xb1dba648,0x3bed3ba8,0x3bdd3bff,0x2648323e,0xb505b0b2,0x3bff3bd9,0x3b993bea,0xad7e2e46,0xb705b444,0x3bf83bf6,0x3b303bb6
.long 0x3c003c00,0x3c003c00,0x0,0x0,0x3be63bea,0x3bdd3be2,0x311530b2,0x31db3179,0x3b993ba8,0x3b773b88,0x350534a5,0x35c23564,0x3b1a3b3b,0x3ad03af6,0x375e36d7,0x383237e3
.long 0x3a6d3aa7,0x39ed3a2f,0x38c43872,0x395f3913,0x399639ed,0x38d8393a,0x39ba395f,0x3a5e3a0f,0x389b3913,0x3732381d,0x3a8a3a2f,0x3b253add,0x3705381d,0x347535c2,0x3b303add,0x3baf3b77
.long 0x34a5361f,0x2e46323e,0x3ba83b64,0x3bf63bd9,0x304e33c6,0xad7e2648,0x3bed3bc3,0x3bf83bff,0xa6482e46,0xb444b0b2,0x3bff3bf6,0x3bb63bea,0xb1dbaa48,0xb705b505,0x3bdd3bfe,0x3b303b99
.long 0xb564b23e,0xb8c4b78b,0x3b883bd9,0x3a6d3b0e,0xb7b7b564,0xb9dcb8ec,0x3b023b88,0x39723a4f,0xb8ecb78b,0xbac2b9ed,0x3a4f3b0e,0x3848395f,0xb9dcb8c4,0xbb6ebac2,0x39723a6d,0x35f13848
.long 0x3bd93c00,0x3aa73b64,0x323e0000,0x3872361f,0x3bd43c00,0x3a7c3b50,0x32a10000,0x38b0367c,0x3bce3c00,0x3a4f3b3b,0x33030000,0x38ec36d7,0x3bc93c00,0x3a1f3b25,0x33650000,0x39273732
.long 0x3bc33c00,0x39ed3b0e,0x33c60000,0x395f378b,0x3bbc3c00,0x39ba3af6,0x34140000,0x399637e3,0x3bb63c00,0x39843add,0x34440000,0x39cb381d,0x3baf3c00,0x394d3ac2,0x34750000,0x39fe3848
.long 0x3ba83c00,0x39133aa7,0x34a50000,0x3a2f3872,0x3ba03c00,0x38d83a8a,0x34d50000,0x3a5e389b,0x3b993c00,0x389b3a6d,0x35050000,0x3a8a38c4,0x3b913c00,0x385d3a4f,0x35340000,0x3ab538ec
.long 0x3b883c00,0x381d3a2f,0x35640000,0x3add3913,0x3b803c00,0x37b73a0f,0x35930000,0x3b02393a,0x3b773c00,0x373239ed,0x35c20000,0x3b25395f,0x3b6e3c00,0x36aa39cb,0x35f10000,0x3b463984
.long 0x387239a8,0x323e361f,0x3aa739a8,0x3bd93b64,0x3807395f,0x2f0e3505,0x3ae939ed,0x3bf43b99,0x37323913,0x264833c6,0x3b253a2f,0x3bff3bc3,0x364e38c4,0xabd93179,0x3b5a3a6d,0x3bfc3be2
.long 0x35643872,0xb0b22e46,0x3b883aa7,0x3bea3bf6,0x3475381d,0xb3652648,0x3baf3add,0x3bc93bff,0x3303378b,0xb505aa48,0x3bce3b0e,0x3b993bfe,0x311536d7,0xb64eafd6,0x3be63b3b,0x3b5a3bf1
.long 0x2e46361f,0xb78bb23e,0x3bf63b64,0x3b0e3bd9,0x28b63564,0xb85db444,0x3bff3b88,0x3ab53bb6,0xa64834a5,0xb8ecb564,0x3bff3ba8,0x3a4f3b88,0xad7e33c6,0xb972b67c,0x3bf83bc3,0x39dc3b50
.long 0xb0b2323e,0xb9edb78b,0x3bea3bd9,0x395f3b0e,0xb2a130b2,0xba5eb848,0x3bd43bea,0x38d83ac2,0xb4442e46,0xbac2b8c4,0x3bb63bf6,0x38483a6d,0xb5342a48,0xbb1ab93a,0x3b913bfe,0x375e3a0f
.long 0xb23e0000,0xb872b61f,0x3bd93c00,0x3aa73b64,0xb4d5ae46,0xb94db7e3,0x3ba03bf6,0x39fe3af6,0xb67cb23e,0xba0fb8c4,0x3b503bd9,0x393a3a6d,0xb807b4a5,0xbab5b984,0x3ae93ba8,0x385d39cb
.long 0xb8c4b61f,0xbb3bba2f,0x3a6d3b64,0x36d73913,0xb972b78b,0xbba0bac2,0x39dc3b0e,0x34d53848,0xba0fb872,0xbbe2bb3b,0x393a3aa7,0x317936d7,0xba99b913,0xbbffbb99,0x38873a2f,0x28b63505
.long 0xbb0eb9a8,0xbbf6bbd9,0x378b39a8,0xae46323e,0xbb6eba2f,0xbbc9bbfa,0x35f13913,0xb3652cb5,0xbbb6baa7,0xbb77bbfe,0x34443872,0xb5c2aa48,0xbbe6bb0e,0xbb02bbe2,0x3115378b,0xb7b7b179
.long 0xbbfebb64,0xba6dbba8,0x2a48361f,0xb8c4b4a5,0xbbfcbba8,0xb9babb50,0xabd934a5,0xb996b67c,0xbbe2bbd9,0xb8ecbadd,0xb179323e,0xba4fb81d,0xbbafbbf6,0xb807ba4f,0xb4752e46,0xbae9b8ec
.long 0xbaa7b9a8,0xbbd9bb64,0x387239a8,0x323e361f,0xbb46ba6d,0xbc00bbce,0x36aa38c4,0x22483303,0xbbb6bb0e,0xbbe2bbfe,0x3444378b,0xb1792a48,0xbbf4bb88,0xbb80bbf1,0x2f0e3564,0xb593afd6
.long 0xbbfebbd9,0xbaddbba8,0xaa48323e,0xb81db4a5,0xbbd4bbfe,0xb9febb25,0xb2a12a48,0xb94db732,0xbb77bbf6,0xb8ecba6d,0xb5c2ae46,0xba4fb8c4,0xbae9bbc3,0xb75eb984,0xb807b3c6,0xbb1ab9cb
.long 0xba2fbb64,0xb4a5b872,0xb913b61f,0xbba8baa7,0xb94dbadd,0xaf0eb67c,0xb9feb81d,0xbbf4bb50,0xb848ba2f,0x2cb5b3c6,0xbac2b913,0xbbfabbc3,0xb64eb95f,0x3414acb5,0xbb5ab9ed,0xbbbcbbfa
.long 0xb3c6b872,0x36d72e46,0xbbc3baa7,0xbb3bbbf6,0xad7eb6d7,0x38b03444,0xbbf8bb3b,0xba7cbbb6,0x2cb5b4a5,0x39cb36d7,0xbbfabba8,0xb984bb3b,0x3365b0b2,0x3ab5389b,0xbbc9bbea,0xb85dba8a
.long 0x28002800,0x28002800,0x0,0x0,0x25a82800,0xa5a80000,0x25a80000,0x25a82800,0x2800,0xa800,0x28000000,0xa8000000,0xa5a82800,0x25a80000,0x25a80000,0x25a8a800
.long 0x27d92800,0x26a72764,0x1e3e0000,0x2472221f,0x24722800,0xa7d9a21f,0x26a70000,0x1e3e2764,0x9e3e2800,0x2472a764,0x27d90000,0xa6a7a21f,0xa6a72800,0x1e3e221f,0x24720000,0x27d9a764
.long 0x27642800,0x221f25a8,0x221f0000,0x276425a8,0x221f2800,0xa764a5a8,0x27640000,0xa21f25a8,0xa21f2800,0x2764a5a8,0x27640000,0xa21fa5a8,0xa7642800,0xa21f25a8,0x221f0000,0x2764a5a8
.long 0x26a72800,0x9e3e221f,0x24720000,0x27d92764,0x1e3e2800,0xa472a764,0x27d90000,0xa6a7221f,0xa4722800,0x27d9a21f,0x26a70000,0x1e3ea764,0xa7d92800,0xa6a72764,0x1e3e0000,0x2472a21f
.long 0x28002800,0x28002800,0x0,0x0,0xa5a8a800,0x25a80000,0xa5a80000,0xa5a8a800,0x2800,0xa800,0x28000000,0xa8000000,0x25a8a800,0xa5a80000,0xa5a80000,0xa5a82800
.long 0x247225a8,0x1e3e221f,0x26a725a8,0x27d92764,0x1e3ea5a8,0x26a72764,0xa7d9a5a8,0x2472a21f,0xa6a725a8,0x27d9a21f,0x247225a8,0x9e3ea764,0x27d9a5a8,0x2472a764,0x1e3ea5a8,0xa6a7221f
.long 0xa21f0000,0xa764a5a8,0x27642800,0x221f25a8,0x27640000,0xa21f25a8,0xa21fa800,0x276425a8,0xa7640000,0x221f25a8,0xa21f2800,0x2764a5a8,0x221f0000,0x2764a5a8,0x2764a800,0x221fa5a8
.long 0xa7d9a5a8,0xa472a764,0x1e3e25a8,0xa6a7a21f,0x26a725a8,0xa7d9a21f,0x2472a5a8,0x9e3e2764,0x9e3ea5a8,0xa6a72764,0xa7d925a8,0x2472221f,0xa47225a8,0x9e3e221f,0x26a7a5a8,0x27d9a764
.long 0x28002800,0x28002800,0x0,0x0,0x25a82800,0xa5a80000,0x25a80000,0x25a82800,0x2800,0xa800,0x28000000,0xa8000000,0xa5a82800,0x25a80000,0x25a80000,0x25a8a800
.long 0x9e3e0000,0xa472a21f,0x27d92800,0x26a72764,0xa6a70000,0x9e3ea764,0x24722800,0xa7d9a21f,0xa7d90000,0x26a7221f,0x9e3e2800,0x2472a764,0xa4720000,0xa7d92764,0xa6a72800,0x1e3e221f
.long 0xa764a800,0xa21fa5a8,0xa21f0000,0xa764a5a8,0xa21fa800,0x276425a8,0xa7640000,0x221fa5a8,0x221fa800,0xa76425a8,0xa7640000,0x221f25a8,0x2764a800,0x221fa5a8,0xa21f0000,0xa76425a8
.long 0x24720000,0x27d92764,0xa6a7a800,0x1e3ea21f,0x27d90000,0xa6a7221f,0x9e3ea800,0x24722764,0x26a70000,0x1e3ea764,0x2472a800,0xa7d9221f,0x1e3e0000,0x2472a21f,0x27d9a800,0x26a7a764
.long 0x28002800,0x28002800,0x0,0x0,0xa5a8a800,0x25a80000,0xa5a80000,0xa5a8a800,0x2800,0xa800,0x28000000,0xa8000000,0x25a8a800,0xa5a80000,0xa5a80000,0xa5a82800
.long 0xa6a7a5a8,0xa7d9a764,0x247225a8,0x1e3e221f,0x27d925a8,0xa472221f,0x1e3ea5a8,0x26a72764,0xa472a5a8,0x1e3e2764,0xa6a725a8,0x27d9a21f,0x9e3e25a8,0x26a7a21f,0x27d9a5a8,0x2472a764
.long 0x221f0000,0x276425a8,0xa764a800,0xa21fa5a8,0xa7640000,0x221fa5a8,0x221f2800,0xa764a5a8,0x27640000,0xa21fa5a8,0x221fa800,0xa76425a8,0xa21f0000,0xa76425a8,0xa7642800,0xa21f25a8
.long 0x1e3e25a8,0xa6a7a21f,0x27d925a8,0x24722764,0x2472a5a8,0x9e3e2764,0xa6a7a5a8,0x27d9221f,0xa7d925a8,0x2472221f,0x1e3e25a8,0x26a7a764,0x26a7a5a8,0x27d9a764,0x2472a5a8,0x1e3ea21f
.long 0x28002800,0x28002800,0x0,0x0,0x25a82800,0xa5a80000,0x25a80000,0x25a82800,0x2800,0xa800,0x28000000,0xa8000000,0xa5a82800,0x25a80000,0x25a80000,0x25a8a800
.long 0xa7d9a800,0xa6a7a764,0x9e3e0000,0xa472a21f,0xa472a800,0x27d9221f,0xa6a70000,0x9e3ea764,0x1e3ea800,0xa4722764,0xa7d90000,0x26a7221f,0x26a7a800,0x9e3ea21f,0xa4720000,0xa7d92764
.long 0x27642800,0x221f25a8,0x221f0000,0x276425a8,0x221f2800,0xa764a5a8,0x27640000,0xa21f25a8,0xa21f2800,0x2764a5a8,0x27640000,0xa21fa5a8,0xa7642800,0xa21f25a8,0x221f0000,0x2764a5a8
.long 0xa6a7a800,0x1e3ea21f,0xa4720000,0xa7d9a764,0x9e3ea800,0x24722764,0xa7d90000,0x26a7a21f,0x2472a800,0xa7d9221f,0xa6a70000,0x9e3e2764,0x27d9a800,0x26a7a764,0x9e3e0000,0xa472221f
.long 0x28002800,0x28002800,0x0,0x0,0xa5a8a800,0x25a80000,0xa5a80000,0xa5a8a800,0x2800,0xa800,0x28000000,0xa8000000,0x25a8a800,0xa5a80000,0xa5a80000,0xa5a82800
.long 0xa472a5a8,0x9e3ea21f,0xa6a7a5a8,0xa7d9a764,0x9e3e25a8,0xa6a7a764,0x27d925a8,0xa472221f,0x26a7a5a8,0xa7d9221f,0xa472a5a8,0x1e3e2764,0xa7d925a8,0xa4722764,0x9e3e25a8,0x26a7a21f
.long 0xa21f0000,0xa764a5a8,0x27642800,0x221f25a8,0x27640000,0xa21f25a8,0xa21fa800,0x276425a8,0xa7640000,0x221f25a8,0xa21f2800,0x2764a5a8,0x221f0000,0x2764a5a8,0x2764a800,0x221fa5a8
.long 0x27d925a8,0x24722764,0x9e3ea5a8,0x26a7221f,0xa6a7a5a8,0x27d9221f,0xa47225a8,0x1e3ea764,0x1e3e25a8,0x26a7a764,0x27d9a5a8,0xa472a21f,0x2472a5a8,0x1e3ea21f,0xa6a725a8,0xa7d92764
.long 0x28002800,0x28002800,0x0,0x0,0x25a82800,0xa5a80000,0x25a80000,0x25a82800,0x2800,0xa800,0x28000000,0xa8000000,0xa5a82800,0x25a80000,0x25a80000,0x25a8a800
.long 0x1e3e0000,0x2472221f,0xa7d9a800,0xa6a7a764,0x26a70000,0x1e3e2764,0xa472a800,0x27d9221f,0x27d90000,0xa6a7a21f,0x1e3ea800,0xa4722764,0x24720000,0x27d9a764,0x26a7a800,0x9e3ea21f
.long 0xa764a800,0xa21fa5a8,0xa21f0000,0xa764a5a8,0xa21fa800,0x276425a8,0xa7640000,0x221fa5a8,0x221fa800,0xa76425a8,0xa7640000,0x221f25a8,0x2764a800,0x221fa5a8,0xa21f0000,0xa76425a8
.long 0xa4720000,0xa7d9a764,0x26a72800,0x9e3e221f,0xa7d90000,0x26a7a21f,0x1e3e2800,0xa472a764,0xa6a70000,0x9e3e2764,0xa4722800,0x27d9a21f,0x9e3e0000,0xa472221f,0xa7d92800,0xa6a72764
.long 0x28002800,0x28002800,0x0,0x0,0xa5a8a800,0x25a80000,0xa5a80000,0xa5a8a800,0x2800,0xa800,0x28000000,0xa8000000,0x25a8a800,0xa5a80000,0xa5a80000,0xa5a82800
.long 0x26a725a8,0x27d92764,0xa472a5a8,0x9e3ea21f,0xa7d9a5a8,0x2472a21f,0x9e3e25a8,0xa6a7a764,0x247225a8,0x9e3ea764,0x26a7a5a8,0xa7d9221f,0x1e3ea5a8,0xa6a7221f,0xa7d925a8,0xa4722764
.long 0x221f0000,0x276425a8,0xa764a800,0xa21fa5a8,0xa7640000,0x221fa5a8,0x221f2800,0xa764a5a8,0x27640000,0xa21fa5a8,0x221fa800,0xa76425a8,0xa21f0000,0xa76425a8,0xa7642800,0xa21f25a8
.long 0x9e3ea5a8,0x26a7221f,0xa7d9a5a8,0xa472a764,0xa47225a8,0x1e3ea764,0x26a725a8,0xa7d9a21f,0x27d9a5a8,0xa472a21f,0x9e3ea5a8,0xa6a72764,0xa6a725a8,0xa7d92764,0xa47225a8,0x9e3e221f
.long 0x3f803f80,0x3f803f80,0x0,0x0,0x3f80,0xbf80,0x3f800000,0xbf800000,0x3f7b3f80,0x3f553f6d,0x3e480000,0x3f0e3ec4,0xbe483f80,0x3f0ebf6d,0x3f7b0000,0xbf55bec4
.long 0x3f6d3f80,0x3ec43f35,0x3ec40000,0x3f6d3f35,0xbec43f80,0x3f6dbf35,0x3f6d0000,0xbec4bf35,0x3f553f80,0xbe483ec4,0x3f0e0000,0x3f7b3f6d,0xbf0e3f80,0x3f7bbec4,0x3f550000,0x3e48bf6d
.long 0x3f353f80,0xbf350000,0x3f350000,0x3f353f80,0xbf353f80,0x3f350000,0x3f350000,0x3f35bf80,0x3f0e3f80,0xbf7bbec4,0x3f550000,0x3e483f6d,0xbf553f80,0x3e483ec4,0x3f0e0000,0x3f7bbf6d
.long 0x3ec43f80,0xbf6dbf35,0x3f6d0000,0xbec43f35,0xbf6d3f80,0xbec43f35,0x3ec40000,0x3f6dbf35,0x3e483f80,0xbf0ebf6d,0x3f7b0000,0xbf553ec4,0xbf7b3f80,0xbf553f6d,0x3e480000,0x3f0ebec4
.long 0x3f803f80,0x3f803f80,0x0,0x0,0x3f80,0xbf80,0x3f800000,0xbf800000,0x3f0e3f35,0x3e483ec4,0x3f553f35,0x3f7b3f6d,0xbf553f35,0x3f7bbec4,0x3f0e3f35,0xbe48bf6d
.long 0xbec40000,0xbf6dbf35,0x3f6d3f80,0x3ec43f35,0xbf6d0000,0x3ec43f35,0xbec43f80,0x3f6dbf35,0xbf7bbf35,0xbf0ebf6d,0x3e483f35,0xbf55bec4,0xbe48bf35,0xbf553f6d,0xbf7b3f35,0x3f0e3ec4
.long 0xbf35bf80,0x3f350000,0xbf350000,0xbf35bf80,0x3f35bf80,0xbf350000,0xbf350000,0xbf353f80,0x3e48bf35,0x3f553f6d,0xbf7bbf35,0x3f0ebec4,0x3f7bbf35,0x3f0ebf6d,0x3e48bf35,0xbf553ec4
.long 0x3f6d0000,0xbec43f35,0xbec4bf80,0x3f6d3f35,0x3ec40000,0x3f6dbf35,0x3f6dbf80,0x3ec4bf35,0x3f553f35,0xbf7bbec4,0x3f0ebf35,0xbe483f6d,0xbf0e3f35,0xbe483ec4,0x3f55bf35,0x3f7bbf6d
.long 0x3f803f80,0x3f803f80,0x0,0x0,0x3f80,0xbf80,0x3f800000,0xbf800000,0xbe480000,0xbf0ebec4,0x3f7b3f80,0x3f553f6d,0xbf7b0000,0x3f553ec4,0xbe483f80,0x3f0ebf6d
.long 0xbf6dbf80,0xbec4bf35,0xbec40000,0xbf6dbf35,0x3ec4bf80,0xbf6d3f35,0xbf6d0000,0x3ec43f35,0x3f0e0000,0x3f7b3f6d,0xbf55bf80,0x3e48bec4,0x3f550000,0x3e48bf6d,0x3f0ebf80,0xbf7b3ec4
.long 0x3f353f80,0xbf350000,0x3f350000,0x3f353f80,0xbf353f80,0x3f350000,0x3f350000,0x3f35bf80,0xbf550000,0xbe48bf6d,0x3f0e3f80,0xbf7bbec4,0xbf0e0000,0xbf7b3f6d,0xbf553f80,0x3e483ec4
.long 0xbec4bf80,0x3f6d3f35,0xbf6d0000,0x3ec4bf35,0x3f6dbf80,0x3ec4bf35,0xbec40000,0xbf6d3f35,0x3f7b0000,0xbf553ec4,0xbe48bf80,0x3f0e3f6d,0x3e480000,0x3f0ebec4,0x3f7bbf80,0x3f55bf6d
.long 0x3f803f80,0x3f803f80,0x0,0x0,0x3f80,0xbf80,0x3f800000,0xbf800000,0xbf55bf35,0xbf7bbf6d,0x3f0e3f35,0x3e483ec4,0xbf0ebf35,0x3e483f6d,0xbf553f35,0x3f7bbec4
.long 0x3ec40000,0x3f6d3f35,0xbf6dbf80,0xbec4bf35,0x3f6d0000,0xbec4bf35,0x3ec4bf80,0xbf6d3f35,0x3e483f35,0xbf55bec4,0x3f7b3f35,0x3f0e3f6d,0xbf7b3f35,0x3f0e3ec4,0x3e483f35,0x3f55bf6d
.long 0xbf35bf80,0x3f350000,0xbf350000,0xbf35bf80,0x3f35bf80,0xbf350000,0xbf350000,0xbf353f80,0x3f7b3f35,0xbf0e3ec4,0x3e48bf35,0x3f553f6d,0xbe483f35,0x3f55bec4,0x3f7bbf35,0x3f0ebf6d
.long 0xbf6d0000,0x3ec4bf35,0x3ec43f80,0xbf6dbf35,0xbec40000,0xbf6d3f35,0xbf6d3f80,0xbec43f35,0x3f0ebf35,0xbe483f6d,0xbf55bf35,0x3f7b3ec4,0x3f55bf35,0x3f7bbf6d,0x3f0ebf35,0x3e48bec4
.long 0x3f803f80,0x3f803f80,0x0,0x0,0x3f80,0xbf80,0x3f800000,0xbf800000,0xbf7bbf80,0xbf55bf6d,0xbe480000,0xbf0ebec4,0x3e48bf80,0xbf0e3f6d,0xbf7b0000,0x3f553ec4
.long 0x3f6d3f80,0x3ec43f35,0x3ec40000,0x3f6d3f35,0xbec43f80,0x3f6dbf35,0x3f6d0000,0xbec4bf35,0xbf55bf80,0x3e48bec4,0xbf0e0000,0xbf7bbf6d,0x3f0ebf80,0xbf7b3ec4,0xbf550000,0xbe483f6d
.long 0x3f353f80,0xbf350000,0x3f350000,0x3f353f80,0xbf353f80,0x3f350000,0x3f350000,0x3f35bf80,0xbf0ebf80,0x3f7b3ec4,0xbf550000,0xbe48bf6d,0x3f55bf80,0xbe48bec4,0xbf0e0000,0xbf7b3f6d
.long 0x3ec43f80,0xbf6dbf35,0x3f6d0000,0xbec43f35,0xbf6d3f80,0xbec43f35,0x3ec40000,0x3f6dbf35,0xbe48bf80,0x3f0e3f6d,0xbf7b0000,0x3f55bec4,0x3f7bbf80,0x3f55bf6d,0xbe480000,0xbf0e3ec4
.long 0x3f803f80,0x3f803f80,0x0,0x0,0x3f80,0xbf80,0x3f800000,0xbf800000,0xbf0ebf35,0xbe48bec4,0xbf55bf35,0xbf7bbf6d,0x3f55bf35,0xbf7b3ec4,0xbf0ebf35,0x3e483f6d
.long 0xbec40000,0xbf6dbf35,0x3f6d3f80,0x3ec43f35,0xbf6d0000,0x3ec43f35,0xbec43f80,0x3f6dbf35,0x3f7b3f35,0x3f0e3f6d,0xbe48bf35,0x3f553ec4,0x3e483f35,0x3f55bf6d,0x3f7bbf35,0xbf0ebec4
.long 0xbf35bf80,0x3f350000,0xbf350000,0xbf35bf80,0x3f35bf80,0xbf350000,0xbf350000,0xbf353f80,0xbe483f35,0xbf55bf6d,0x3f7b3f35,0xbf0e3ec4,0xbf7b3f35,0xbf0e3f6d,0xbe483f35,0x3f55bec4
.long 0x3f6d0000,0xbec43f35,0xbec4bf80,0x3f6d3f35,0x3ec40000,0x3f6dbf35,0x3f6dbf80,0x3ec4bf35,0xbf55bf35,0x3f7b3ec4,0xbf0e3f35,0x3e48bf6d,0x3f0ebf35,0x3e48bec4,0xbf553f35,0xbf7b3f6d
.long 0x3f803f80,0x3f803f80,0x0,0x0,0x3f80,0xbf80,0x3f800000,0xbf800000,0x3e480000,0x3f0e3ec4,0xbf7bbf80,0xbf55bf6d,0x3f7b0000,0xbf55bec4,0x3e48bf80,0xbf0e3f6d
.long 0xbf6dbf80,0xbec4bf35,0xbec40000,0xbf6dbf35,0x3ec4bf80,0xbf6d3f35,0xbf6d0000,0x3ec43f35,0xbf0e0000,0xbf7bbf6d,0x3f553f80,0xbe483ec4,0xbf550000,0xbe483f6d,0xbf0e3f80,0x3f7bbec4
.long 0x3f353f80,0xbf350000,0x3f350000,0x3f353f80,0xbf353f80,0x3f350000,0x3f350000,0x3f35bf80,0x3f550000,0x3e483f6d,0xbf0ebf80,0x3f7b3ec4,0x3f0e0000,0x3f7bbf6d,0x3f55bf80,0xbe48bec4
.long 0xbec4bf80,0x3f6d3f35,0xbf6d0000,0x3ec4bf35,0x3f6dbf80,0x3ec4bf35,0xbec40000,0xbf6d3f35,0xbf7b0000,0x3f55bec4,0x3e483f80,0xbf0ebf6d,0xbe480000,0xbf0e3ec4,0xbf7b3f80,0xbf553f6d
.long 0x3f803f80,0x3f803f80,0x0,0x0,0x3f80,0xbf80,0x3f800000,0xbf800000,0x3f553f35,0x3f7b3f6d,0xbf0ebf35,0xbe48bec4,0x3f0e3f35,0xbe48bf6d,0x3f55bf35,0xbf7b3ec4
.long 0x3ec40000,0x3f6d3f35,0xbf6dbf80,0xbec4bf35,0x3f6d0000,0xbec4bf35,0x3ec4bf80,0xbf6d3f35,0xbe48bf35,0x3f553ec4,0xbf7bbf35,0xbf0ebf6d,0x3f7bbf35,0xbf0ebec4,0xbe48bf35,0xbf553f6d
.long 0xbf35bf80,0x3f350000,0xbf350000,0xbf35bf80,0x3f35bf80,0xbf350000,0xbf350000,0xbf353f80,0xbf7bbf35,0x3f0ebec4,0xbe483f35,0xbf55bf6d,0x3e48bf35,0xbf553ec4,0xbf7b3f35,0xbf0e3f6d
.long 0xbf6d0000,0x3ec4bf35,0x3ec43f80,0xbf6dbf35,0xbec40000,0xbf6d3f35,0xbf6d3f80,0xbec43f35,0xbf0e3f35,0x3e48bf6d,0x3f553f35,0xbf7bbec4,0xbf553f35,0xbf7b3f6d,0xbf0e3f35,0xbe483ec4
.long 0x3f803f80,0x3f803f80,0x80008000,0x80008000,0x3f80,0xbf80,0xbf808000,0x3f808000,0xbf803f80,0xbf803f80,0x80008000,0x80008000,0x3f80,0xbf80,0x3f808000,0xbf808000
.long 0x3f803f80,0x3f803f80,0x80008000,0x80008000,0x3f80,0xbf80,0xbf808000,0x3f808000,0xbf803f80,0xbf803f80,0x80008000,0x80008000,0x3f80,0xbf80,0x3f808000,0xbf808000
.long 0x3f803f80,0x3f803f80,0x80008000,0x80008000,0x3f80,0xbf80,0xbf808000,0x3f808000,0xbf803f80,0xbf803f80,0x80008000,0x80008000,0x3f80,0xbf80,0x3f808000,0xbf808000
.long 0x3f803f80,0x3f803f80,0x80008000,0x80008000,0x3f80,0xbf80,0xbf808000,0x3f808000,0xbf803f80,0xbf803f80,0x80008000,0x80008000,0x3f80,0xbf80,0x3f808000,0xbf808000
.long 0x3f803f80,0x3f803f80,0x80008000,0x80008000,0xbec43f6d,0x3ec4bf6d,0xbf6dbec4,0x3f6d3ec4,0xbf353f35,0xbf353f35,0x3f35bf35,0x3f35bf35,0x3f6d3ec4,0xbf6dbec4,0x3ec4bf6d,0xbec43f6d
.long 0x0,0x0,0xbf80bf80,0xbf80bf80,0xbf6dbec4,0x3f6d3ec4,0x3ec4bf6d,0xbec43f6d,0x3f35bf35,0x3f35bf35,0x3f35bf35,0x3f35bf35,0x3ec4bf6d,0xbec43f6d,0xbf6dbec4,0x3f6d3ec4
.long 0xbf80bf80,0xbf80bf80,0x80008000,0x80008000,0x3ec4bf6d,0xbec43f6d,0x3f6d3ec4,0xbf6dbec4,0x3f35bf35,0x3f35bf35,0xbf353f35,0xbf353f35,0xbf6dbec4,0x3f6d3ec4,0xbec43f6d,0x3ec4bf6d
.long 0x0,0x0,0x3f803f80,0x3f803f80,0x3f6d3ec4,0xbf6dbec4,0xbec43f6d,0x3ec4bf6d,0xbf353f35,0xbf353f35,0xbf353f35,0xbf353f35,0xbec43f6d,0x3ec4bf6d,0x3f6d3ec4,0xbf6dbec4
.long 0x3f803f80,0x3f803f80,0x80008000,0x80008000,0xbf353f35,0x3f35bf35,0xbf35bf35,0x3f353f35,0x0,0x0,0x3f80bf80,0x3f80bf80,0x3f35bf35,0xbf353f35,0xbf35bf35,0x3f353f35
.long 0xbf80bf80,0xbf80bf80,0x80008000,0x80008000,0x3f35bf35,0xbf353f35,0x3f353f35,0xbf35bf35,0x0,0x0,0xbf803f80,0xbf803f80,0xbf353f35,0x3f35bf35,0x3f353f35,0xbf35bf35
.long 0x3f803f80,0x3f803f80,0x80008000,0x80008000,0xbf353f35,0x3f35bf35,0xbf35bf35,0x3f353f35,0x0,0x0,0x3f80bf80,0x3f80bf80,0x3f35bf35,0xbf353f35,0xbf35bf35,0x3f353f35
.long 0xbf80bf80,0xbf80bf80,0x80008000,0x80008000,0x3f35bf35,0xbf353f35,0x3f353f35,0xbf35bf35,0x0,0x0,0xbf803f80,0xbf803f80,0xbf353f35,0x3f35bf35,0x3f353f35,0xbf35bf35
.long 0x3f803f80,0x3f803f80,0x80008000,0x80008000,0xbf6d3ec4,0x3f6dbec4,0xbec4bf6d,0x3ec43f6d,0x3f35bf35,0x3f35bf35,0x3f35bf35,0x3f35bf35,0xbec4bf6d,0x3ec43f6d,0xbf6d3ec4,0x3f6dbec4
.long 0x0,0x0,0x3f803f80,0x3f803f80,0x3ec43f6d,0xbec4bf6d,0xbf6d3ec4,0x3f6dbec4,0xbf353f35,0xbf353f35,0x3f35bf35,0x3f35bf35,0x3f6dbec4,0xbf6d3ec4,0xbec4bf6d,0x3ec43f6d
.long 0xbf80bf80,0xbf80bf80,0x80008000,0x80008000,0x3f6dbec4,0xbf6d3ec4,0x3ec43f6d,0xbec4bf6d,0xbf353f35,0xbf353f35,0xbf353f35,0xbf353f35,0x3ec43f6d,0xbec4bf6d,0x3f6dbec4,0xbf6d3ec4
.long 0x0,0x0,0xbf80bf80,0xbf80bf80,0xbec4bf6d,0x3ec43f6d,0x3f6dbec4,0xbf6d3ec4,0x3f35bf35,0x3f35bf35,0xbf353f35,0xbf353f35,0xbf6d3ec4,0x3f6dbec4,0x3ec43f6d,0xbec4bf6d
.long 0x3f80,0x0,0x0,0x0,0x3f800000,0x0,0x0,0x0,0x0,0x3f80,0x0,0x0,0x0,0x3f800000,0x0,0x0
.long 0x0,0x0,0x3f80,0x0,0x0,0x0,0x3f800000,0x0,0x0,0x0,0x0,0x3f80,0x0,0x0,0x0,0x3f800000
.long 0x0,0x0,0x0,0x0,0x0,0x0,0x0,0x0,0x0,0x0,0x0,0x0,0x0,0x0,0x0,0x0
.long 0x0,0x0,0x0,0x0,0x0,0x0,0x0,0x0,0x0,0x0,0x0,0x0,0x0,0x0,0x0,0x0
.long 0x3f80,0x0,0x0,0x0,0x3f800000,0x0,0x0,0x0,0x0,0x3f80,0x0,0x0,0x0,0x3f800000,0x0,0x0
.long 0x0,0x0,0x3f80,0x0,0x0,0x0,0x3f800000,0x0,0x0,0x0,0x0,0x3f80,0x0,0x0,0x0,0x3f800000
.long 0x0,0x0,0x0,0x0,0x0,0x0,0x0,0x0,0x0,0x0,0x0,0x0,0x0,0x0,0x0,0x0
.long 0x0,0x0,0x0,0x0,0x0,0x0,0x0,0x0,0x0,0x0,0x0,0x0,0x0,0x0,0x0,0x0
.long 0x3f80,0x0,0x0,0x0,0x3f800000,0x0,0x0,0x0,0x0,0x3f80,0x0,0x0,0x0,0x3f800000,0x0,0x0
.long 0x0,0x0,0x3f80,0x0,0x0,0x0,0x3f800000,0x0,0x0,0x0,0x0,0x3f80,0x0,0x0,0x0,0x3f800000
.long 0x0,0x0,0x0,0x0,0x0,0x0,0x0,0x0,0x0,0x0,0x0,0x0,0x0,0x0,0x0,0x0
.long 0x0,0x0,0x0,0x0,0x0,0x0,0x0,0x0,0x0,0x0,0x0,0x0,0x0,0x0,0x0,0x0
.long 0x3f80,0x0,0x0,0x0,0x3f800000,0x0,0x0,0x0,0x0,0x3f80,0x0,0x0,0x0,0x3f800000,0x0,0x0
.long 0x0,0x0,0x3f80,0x0,0x0,0x0,0x3f800000,0x0,0x0,0x0,0x0,0x3f80,0x0,0x0,0x0,0x3f800000
.long 0x0,0x0,0x0,0x0,0x0,0x0,0x0,0x0,0x0,0x0,0x0,0x0,0x0,0x0,0x0,0x0
.long 0x0,0x0,0x0,0x0,0x0,0x0,0x0,0x0,0x0,0x0,0x0,0x0,0x0,0x0,0x0,0x0
.long 0x3f800000,0x3f800000,0x3f800000,0x3f800000,0x3f800000,0x3f7ffb11,0x3f7fec43,0x3f7fd397,0x3f800000,0x3f7fec43,0x3f7fb10f,0x3f7f4e6d,0x3f800000,0x3f7fd397,0x3f7f4e6d,0x3f7e70b0
.long 0x3f800000,0x3f7fb10f,0x3f7ec46d,0x3f7d3aac,0x3f800000,0x3f7f84ab,0x3f7e1324,0x3f7baccd,0x3f800000,0x3f7f4e6d,0x3f7d3aac,0x3f79c79d,0x3f800000,0x3f7f0e58,0x3f7c3b28,0x3f778bc5
.long 0x3f800000,0x3f7ec46d,0x3f7b14be,0x3f74fa0b,0x3f800000,0x3f7e70b0,0x3f79c79d,0x3f721352,0x3f800000,0x3f7e1324,0x3f7853f8,0x3f6ed89e,0x3f800000,0x3f7dabcc,0x3f76ba07,0x3f6b4b0c
.long 0x3f800000,0x3f7d3aac,0x3f74fa0b,0x3f676bd8,0x3f800000,0x3f7cbfc9,0x3f731447,0x3f633c5a,0x3f800000,0x3f7c3b28,0x3f710908,0x3f5ebe05,0x3f800000,0x3f7baccd,0x3f6ed89e,0x3f59f26a
.long 0x3f800000,0x3f800000,0x3f800000,0x3f800000,0x3f7fb10f,0x3f7f84ab,0x3f7f4e6d,0x3f7f0e58,0x3f7ec46d,0x3f7e1324,0x3f7d3aac,0x3f7c3b28,0x3f7d3aac,0x3f7baccd,0x3f79c79d,0x3f778bc5
.long 0x3f7b14be,0x3f7853f8,0x3f74fa0b,0x3f710908,0x3f7853f8,0x3f740bdd,0x3f6ed89e,0x3f68bf3c,0x3f74fa0b,0x3f6ed89e,0x3f676bd8,0x3f5ebe05,0x3f710908,0x3f68bf3c,0x3f5ebe05,0x3f531849
.long 0x3f6c835e,0x3f61c598,0x3f54db31,0x3f45e403,0x3f676bd8,0x3f59f26a,0x3f49d112,0x3f373a23,0x3f61c598,0x3f514d3d,0x3f3daef9,0x3f273656,0x3f5b941a,0x3f47de65,0x3f3085bb,0x3f15f6d9
.long 0x3f54db31,0x3f3daef9,0x3f226799,0x3f039c3d,0x3f4d9f02,0x3f32c8c9,0x3f13682a,0x3ee0924f,0x3f45e403,0x3f273656,0x3f039c3d,0x3eb8442a,0x3f3daef9,0x3f1b02c6,0x3ee63375,0x3e8e9a22
.long 0x3f800000,0x3f800000,0x3f800000,0x3f800000,0x3f7ec46d,0x3f7e70b0,0x3f7e1324,0x3f7dabcc,0x3f7b14be,0x3f79c79d,0x3f7853f8,0x3f76ba07,0x3f74fa0b,0x3f721352,0x3f6ed89e,0x3f6b4b0c
.long 0x3f6c835e,0x3f676bd8,0x3f61c598,0x3f5b941a,0x3f61c598,0x3f59f26a,0x3f514d3d,0x3f47de65,0x3f54db31,0x3f49d112,0x3f3daef9,0x3f3085bb,0x3f45e403,0x3f373a23,0x3f273656,0x3f15f6d9
.long 0x3f3504f3,0x3f226799,0x3f0e39da,0x3ef15aea,0x3f226799,0x3f0b9a6b,0x3ee63375,0x3eb263ef,0x3f0e39da,0x3ee63375,0x3eac7cd4,0x3e605c13,0x3ef15aea,0x3eb263ef,0x3e605c13,0x3dafb680
.long 0x3ec3ef15,0x3e78cfcc,0x3dc8bd36,0xbd48fb30,0x3e94a031,0x3e09cf86,0xbcc90ab0,0xbe3b6ecf,0x3e47c5c2,0x3cc90ab0,0xbe164083,0xbea09ae5,0x3dc8bd36,0xbdafb680,0xbe888e93,0xbee0924f
.long 0x3f800000,0x3f800000,0x3f800000,0x3f800000,0x3f7d3aac,0x3f7cbfc9,0x3f7c3b28,0x3f7baccd,0x3f74fa0b,0x3f731447,0x3f710908,0x3f6ed89e,0x3f676bd8,0x3f633c5a,0x3f5ebe05,0x3f59f26a
.long 0x3f54db31,0x3f4d9f02,0x3f45e403,0x3f3daef9,0x3f3daef9,0x3f32c8c9,0x3f273656,0x3f1b02c6,0x3f226799,0x3f13682a,0x3f039c3d,0x3ee63375,0x3f039c3d,0x3ee0924f,0x3eb8442a,0x3e8e9a22
.long 0x3ec3ef15,0x3e94a031,0x3e47c5c2,0x3dc8bd36,0x3e78cfcc,0x3e09cf86,0x3cc90ab0,0xbdafb680,0x3dc8bd36,0xbcc90ab0,0xbe164083,0xbe888e93,0xbd48fb30,0xbe3b6ecf,0xbea09ae5,0xbee0924f
.long 0xbe47c5c2,0xbeac7cd4,0xbef15aea,0xbf187fc0,0xbeac7cd4,0xbef6e0cb,0xbf1d7fd1,0xbf3b8f3b,0xbef15aea,0xbf1d7fd1,0xbf3daef9,0xbf584853,0xbf187fc0,0xbf3b8f3b,0xbf584853,0xbf6db293
.long 0x0,0x0,0x0,0x0,0x0,0x3c490e90,0x3cc90ab0,0x3d16c32c,0x0,0x3cc90ab0,0x3d48fb30,0x3d96a905,0x0,0x3d16c32c,0x3d96a905,0x3de1bc2e
.long 0x0,0x3d48fb30,0x3dc8bd36,0x3e164083,0x0,0x3d7b2b74,0x3dfab273,0x3e3b6ecf,0x0,0x3d96a905,0x3e164083,0x3e605c13,0x0,0x3dafb680,0x3e2f10a2,0x3e827dc0
.long 0x0,0x3dc8bd36,0x3e47c5c2,0x3e94a031,0x0,0x3de1bc2e,0x3e605c13,0x3ea68f12,0x0,0x3dfab273,0x3e78cfcc,0x3eb8442a,0x0,0x3e09cf86,0x3e888e93,0x3ec9b953
.long 0x0,0x3e164083,0x3e94a031,0x3edae880,0x0,0x3e22abb6,0x3ea09ae5,0x3eebcbbb,0x0,0x3e2f10a2,0x3eac7cd4,0x3efc5d27,0x0,0x3e3b6ecf,0x3eb8442a,0x3f064b82
.long 0x0,0x0,0x0,0x0,0x3d48fb30,0x3d7b2b74,0x3d96a905,0x3dafb680,0x3dc8bd36,0x3dfab273,0x3e164083,0x3e2f10a2,0x3e164083,0x3e3b6ecf,0x3e605c13,0x3e827dc0
.long 0x3e47c5c2,0x3e78cfcc,0x3e94a031,0x3eac7cd4,0x3e78cfcc,0x3e9aa086,0x3eb8442a,0x3ed53641,0x3e94a031,0x3eb8442a,0x3edae880,0x3efc5d27,0x3eac7cd4,0x3ed53641,0x3efc5d27,0x3f10d3cd
.long 0x3ec3ef15,0x3ef15aea,0x3f0e39da,0x3f226799,0x3edae880,0x3f064b82,0x3f1d7fd1,0x3f32c8c9,0x3ef15aea,0x3f13682a,0x3f2beb4a,0x3f41d870,0x3f039c3d,0x3f1ff6cb,0x3f396842,0x3f4f7a1f
.long 0x3f0e39da,0x3f2beb4a,0x3f45e403,0x3f5b941a,0x3f187fc0,0x3f373a23,0x3f514d3d,0x3f660f88,0x3f226799,0x3f41d870,0x3f5b941a,0x3f6ed89e,0x3f2beb4a,0x3f4bbbf8,0x3f64aa59,0x3f75dec6
.long 0x0,0x0,0x0,0x0,0x3dc8bd36,0x3de1bc2e,0x3dfab273,0x3e09cf86,0x3e47c5c2,0x3e605c13,0x3e78cfcc,0x3e888e93,0x3e94a031,0x3ea68f12,0x3eb8442a,0x3ec9b953
.long 0x3ec3ef15,0x3edae880,0x3ef15aea,0x3f039c3d,0x3ef15aea,0x3f064b82,0x3f13682a,0x3f1ff6cb,0x3f0e39da,0x3f1d7fd1,0x3f2beb4a,0x3f396842,0x3f226799,0x3f32c8c9,0x3f41d870,0x3f4f7a1f
.long 0x3f3504f3,0x3f45e403,0x3f54db31,0x3f61c598,0x3f45e403,0x3f5695e5,0x3f64aa59,0x3f6ff573,0x3f54db31,0x3f64aa59,0x3f710908,0x3f79c79d,0x3f61c598,0x3f6ff573,0x3f79c79d,0x3f7f0e58
.long 0x3f6c835e,0x3f7853f8,0x3f7ec46d,0x3f7fb10f,0x3f74fa0b,0x3f7dabcc,0x3f7fec43,0x3f7baccd,0x3f7b14be,0x3f7fec43,0x3f7d3aac,0x3f731447,0x3f7ec46d,0x3f7f0e58,0x3f76ba07,0x3f660f88
.long 0x0,0x0,0x0,0x0,0x3e164083,0x3e22abb6,0x3e2f10a2,0x3e3b6ecf,0x3e94a031,0x3ea09ae5,0x3eac7cd4,0x3eb8442a,0x3edae880,0x3eebcbbb,0x3efc5d27,0x3f064b82
.long 0x3f0e39da,0x3f187fc0,0x3f226799,0x3f2beb4a,0x3f2beb4a,0x3f373a23,0x3f41d870,0x3f4bbbf8,0x3f45e403,0x3f514d3d,0x3f5b941a,0x3f64aa59,0x3f5b941a,0x3f660f88,0x3f6ed89e,0x3f75dec6
.long 0x3f6c835e,0x3f74fa0b,0x3f7b14be,0x3f7ec46d,0x3f7853f8,0x3f7dabcc,0x3f7fec43,0x3f7f0e58,0x3f7ec46d,0x3f7fec43,0x3f7d3aac,0x3f76ba07,0x3f7fb10f,0x3f7baccd,0x3f731447,0x3f660f88
.long 0x3f7b14be,0x3f710908,0x3f61c598,0x3f4d9f02,0x3f710908,0x3f604621,0x3f49d112,0x3f2e3bde,0x3f61c598,0x3f49d112,0x3f2beb4a,0x3f08f59b,0x3f4d9f02,0x3f2e3bde,0x3f08f59b,0x3ebe1d4a
.long 0x3f800000,0x3f800000,0x3f800000,0x3f800000,0x3f7b14be,0x3f7a7302,0x3f79c79d,0x3f791298,0x3f6c835e,0x3f6a09a7,0x3f676bd8,0x3f64aa59,0x3f54db31,0x3f4f7a1f,0x3f49d112,0x3f43e200
.long 0x3f3504f3,0x3f2beb4a,0x3f226799,0x3f187fc0,0x3f0e39da,0x3f00e7e4,0x3ee63375,0x3ec9b953,0x3ec3ef15,0x3ea09ae5,0x3e78cfcc,0x3e2f10a2,0x3e47c5c2,0x3de1bc2e,0x3cc90ab0,0xbd7b2b74
.long 0x0,0xbdc8bd36,0xbe47c5c2,0xbe94a031,0xbe47c5c2,0xbe9aa086,0xbecf7bca,0xbf00e7e4,0xbec3ef15,0xbefc5d27,0xbf187fc0,0xbf3085bb,0xbf0e39da,0xbf299415,0xbf41d870,0xbf5695e5
.long 0xbf3504f3,0xbf4d9f02,0xbf61c598,0xbf710908,0xbf54db31,0xbf68bf3c,0xbf76ba07,0xbf7e70b0,0xbf6c835e,0xbf79c79d,0xbf7fb10f,0xbf7e1324,0xbf7b14be,0xbf7ffb11,0xbf7c3b28,0xbf6ff573
.long 0x3f800000,0x3f800000,0x3f800000,0x3f800000,0x3f7853f8,0x3f778bc5,0x3f76ba07,0x3f75dec6,0x3f61c598,0x3f5ebe05,0x3f5b941a,0x3f584853,0x3f3daef9,0x3f373a23,0x3f3085bb,0x3f299415
.long 0x3f0e39da,0x3f039c3d,0x3ef15aea,0x3edae880,0x3eac7cd4,0x3e8e9a22,0x3e605c13,0x3e22abb6,0x3dc8bd36,0x3cc90ab0,0xbd48fb30,0xbdfab273,0xbe164083,0xbe6c9a7f,0xbea09ae5,0xbec9b953
.long 0xbec3ef15,0xbef15aea,0xbf0e39da,0xbf226799,0xbf187fc0,0xbf2e3bde,0xbf41d870,0xbf531849,0xbf45e403,0xbf584853,0xbf676bd8,0xbf731447,0xbf676bd8,0xbf740bdd,0xbf7c3b28,0xbf7fd397
.long 0xbf7b14be,0xbf7fb10f,0xbf7ec46d,0xbf7853f8,0xbf7fb10f,0xbf7a7302,0xbf6ed89e,0xbf5d2d53,0xbf74fa0b,0xbf64aa59,0xbf4d9f02,0xbf3085bb,0xbf5b941a,0xbf3fc767,0xbf1d7fd1,0xbeebcbbb
.long 0x3f800000,0x3f800000,0x3f800000,0x3f800000,0x3f74fa0b,0x3f740bdd,0x3f731447,0x3f721352,0x3f54db31,0x3f514d3d,0x3f4d9f02,0x3f49d112,0x3f226799,0x3f1b02c6,0x3f13682a,0x3f0b9a6b
.long 0x3ec3ef15,0x3eac7cd4,0x3e94a031,0x3e78cfcc,0x3dc8bd36,0x3d16c32c,0xbcc90ab0,0xbdafb680,0xbe47c5c2,0xbe888e93,0xbeac7cd4,0xbecf7bca,0xbef15aea,0xbf0b9a6b,0xbf1d7fd1,0xbf2e3bde
.long 0xbf3504f3,0xbf45e403,0xbf54db31,0xbf61c598,0xbf61c598,0xbf6db293,0xbf76ba07,0xbf7cbfc9,0xbf7b14be,0xbf7f4e6d,0xbf7fb10f,0xbf7c3b28,0xbf7ec46d,0xbf791298,0xbf6ed89e,0xbf604621
.long 0xbf6c835e,0xbf5b941a,0xbf45e403,0xbf2beb4a,0xbf45e403,0xbf299415,0xbf08f59b,0xbec9b953,0xbf0e39da,0xbecf7bca,0xbe78cfcc,0xbd96a905,0xbe94a031,0xbde1bc2e,0x3d96a905,0x3e827dc0
.long 0x3f800000,0x3f800000,0x3f800000,0x3f800000,0x3f710908,0x3f6ff573,0x3f6ed89e,0x3f6db293,0x3f45e403,0x3f41d870,0x3f3daef9,0x3f396842,0x3f039c3d,0x3ef6e0cb,0x3ee63375,0x3ed53641
.long 0x3e47c5c2,0x3e164083,0x3dc8bd36,0x3d48fb30,0xbe164083,0xbe541501,0xbe888e93,0xbea68f12,0xbef15aea,0xbf08f59b,0xbf187fc0,0xbf273656,0xbf3daef9,0xbf4bbbf8,0xbf584853,0xbf633c5a
.long 0xbf6c835e,0xbf74fa0b,0xbf7b14be,0xbf7ec46d,0xbf7fb10f,0xbf7f84ab,0xbf7c3b28,0xbf75dec6,0xbf74fa0b,0xbf6a09a7,0xbf5b941a,0xbf49d112,0xbf4d9f02,0xbf373a23,0xbf1d7fd1,0xbf00e7e4
.long 0xbf0e39da,0xbedae880,0xbe94a031,0xbe164083,0xbe78cfcc,0xbdafb680,0x3d96a905,0x3e6c9a7f,0x3dc8bd36,0x3e888e93,0x3edae880,0x3f13682a,0x3edae880,0x3f15f6d9,0x3f396842,0x3f5695e5
.long 0x0,0x0,0x0,0x0,0x3e47c5c2,0x3e541501,0x3e605c13,0x3e6c9a7f,0x3ec3ef15,0x3ecf7bca,0x3edae880,0x3ee63375,0x3f0e39da,0x3f15f6d9,0x3f1d7fd1,0x3f24d225
.long 0x3f3504f3,0x3f3daef9,0x3f45e403,0x3f4d9f02,0x3f54db31,0x3f5d2d53,0x3f64aa59,0x3f6b4b0c,0x3f6c835e,0x3f731447,0x3f7853f8,0x3f7c3b28,0x3f7b14be,0x3f7e70b0,0x3f7fec43,0x3f7f84ab
.long 0x3f800000,0x3f7ec46d,0x3f7b14be,0x3f74fa0b,0x3f7b14be,0x3f740bdd,0x3f6a09a7,0x3f5d2d53,0x3f6c835e,0x3f5ebe05,0x3f4d9f02,0x3f396842,0x3f54db31,0x3f3fc767,0x3f273656,0x3f0b9a6b
.long 0x3f3504f3,0x3f187fc0,0x3ef15aea,0x3eac7cd4,0x3f0e39da,0x3ed53641,0x3e888e93,0x3de1bc2e,0x3ec3ef15,0x3e605c13,0x3d48fb30,0xbdfab273,0x3e47c5c2,0x3c490e90,0xbe2f10a2,0xbeb263ef
.long 0x0,0x0,0x0,0x0,0x3e78cfcc,0x3e827dc0,0x3e888e93,0x3e8e9a22,0x3ef15aea,0x3efc5d27,0x3f039c3d,0x3f08f59b,0x3f2beb4a,0x3f32c8c9,0x3f396842,0x3f3fc767
.long 0x3f54db31,0x3f5b941a,0x3f61c598,0x3f676bd8,0x3f710908,0x3f75dec6,0x3f79c79d,0x3f7cbfc9,0x3f7ec46d,0x3f7fec43,0x3f7fb10f,0x3f7e1324,0x3f7d3aac,0x3f791298,0x3f731447,0x3f6b4b0c
.long 0x3f6c835e,0x3f61c598,0x3f54db31,0x3f45e403,0x3f4d9f02,0x3f3b8f3b,0x3f273656,0x3f10d3cd,0x3f226799,0x3f08f59b,0x3edae880,0x3ea09ae5,0x3edae880,0x3e9aa086,0x3e2f10a2,0x3d16c32c
.long 0x3e47c5c2,0x3d48fb30,0xbdc8bd36,0xbe78cfcc,0xbd48fb30,0xbe541501,0xbeb8442a,0xbf00e7e4,0xbe94a031,0xbee63375,0xbf187fc0,0xbf396842,0xbf039c3d,0xbf299415,0xbf49d112,0xbf633c5a
.long 0x0,0x0,0x0,0x0,0x3e94a031,0x3e9aa086,0x3ea09ae5,0x3ea68f12,0x3f0e39da,0x3f13682a,0x3f187fc0,0x3f1d7fd1,0x3f45e403,0x3f4bbbf8,0x3f514d3d,0x3f5695e5
.long 0x3f6c835e,0x3f710908,0x3f74fa0b,0x3f7853f8,0x3f7ec46d,0x3f7fd397,0x3f7fec43,0x3f7f0e58,0x3f7b14be,0x3f76ba07,0x3f710908,0x3f6a09a7,0x3f61c598,0x3f5695e5,0x3f49d112,0x3f3b8f3b
.long 0x3f3504f3,0x3f226799,0x3f0e39da,0x3ef15aea,0x3ef15aea,0x3ebe1d4a,0x3e888e93,0x3e22abb6,0x3e47c5c2,0x3d96a905,0xbd48fb30,0xbe2f10a2,0xbdc8bd36,0xbe6c9a7f,0xbeb8442a,0xbef6e0cb
.long 0xbec3ef15,0xbf039c3d,0xbf226799,0xbf3daef9,0xbf226799,0xbf3fc767,0xbf584853,0xbf6b4b0c,0xbf54db31,0xbf6a09a7,0xbf7853f8,0xbf7f4e6d,0xbf74fa0b,0xbf7e70b0,0xbf7f4e6d,0xbf778bc5
.long 0x0,0x0,0x0,0x0,0x3eac7cd4,0x3eb263ef,0x3eb8442a,0x3ebe1d4a,0x3f226799,0x3f273656,0x3f2beb4a,0x3f3085bb,0x3f5b941a,0x3f604621,0x3f64aa59,0x3f68bf3c
.long 0x3f7b14be,0x3f7d3aac,0x3f7ec46d,0x3f7fb10f,0x3f7d3aac,0x3f7a7302,0x3f76ba07,0x3f721352,0x3f61c598,0x3f584853,0x3f4d9f02,0x3f41d870,0x3f2beb4a,0x3f1b02c6,0x3f08f59b,0x3eebcbbb
.long 0x3ec3ef15,0x3e94a031,0x3e47c5c2,0x3dc8bd36,0x3d48fb30,0xbd7b2b74,0xbe2f10a2,0xbe8e9a22,0xbe94a031,0xbecf7bca,0xbf039c3d,0xbf1d7fd1,0xbf187fc0,0xbf32c8c9,0xbf49d112,0xbf5d2d53
.long 0xbf54db31,0xbf676bd8,0xbf74fa0b,0xbf7d3aac,0xbf7853f8,0xbf7f0e58,0xbf7f4e6d,0xbf791298,0xbf7ec46d,0xbf76ba07,0xbf676bd8,0xbf514d3d,0xbf676bd8,0xbf4f7a1f,0xbf3085bb,0xbf0b9a6b
.long 0x0,0x0,0x0,0x0,0x0,0x0,0x0,0x0,0x0,0x0,0x0,0x0,0x0,0x0,0x0,0x0
.long 0x0,0x0,0x0,0x0,0x0,0x0,0x0,0x0,0x0,0x0,0x0,0x0,0x0,0x0,0x0,0x0
.long 0x0,0x0,0x0,0x0,0x0,0x0,0x0,0x0,0x0,0x0,0x0,0x0,0x0,0x0,0x0,0x0
.long 0x0,0x0,0x0,0x0,0x0,0x0,0x0,0x0,0x0,0x0,0x0,0x0,0x0,0x0,0x0,0x0
.long 0x0,0x0,0x0,0x0,0x0,0x0,0x0,0x0,0x0,0x0,0x0,0x0,0x0,0x0,0x0,0x0
.long 0x0,0x0,0x0,0x0,0x0,0x0,0x0,0x0,0x0,0x0,0x0,0x0,0x0,0x0,0x0,0x0
.long 0x0,0x0,0x0,0x0,0x0,0x0,0x0,0x0,0x0,0x0,0x0,0x0,0x0,0x0,0x0,0x0
.long 0x0,0x0,0x0,0x0,0x0,0x0,0x0,0x0,0x0,0x0,0x0,0x0,0x0,0x0,0x0,0x0
.long 0x0,0x0,0x0,0x0,0x0,0x0,0x0,0x0,0x0,0x0,0x0,0x0,0x0,0x0,0x0,0x0
.long 0x0,0x0,0x0,0x0,0x0,0x0,0x0,0x0,0x0,0x0,0x0,0x0,0x0,0x0,0x0,0x0
.long 0x0,0x0,0x0,0x0,0x0,0x0,0x0,0x0,0x0,0x0,0x0,0x0,0x0,0x0,0x0,0x0
.long 0x0,0x0,0x0,0x0,0x0,0x0,0x0,0x0,0x0,0x0,0x0,0x0,0x0,0x0,0x0,0x0
.long 0x0,0x0,0x0,0x0,0x0,0x0,0x0,0x0,0x0,0x0,0x0,0x0,0x0,0x0,0x0,0x0
.long 0x0,0x0,0x0,0x0,0x0,0x0,0x0,0x0,0x0,0x0,0x0,0x0,0x0,0x0,0x0,0x0
.long 0x0,0x0,0x0,0x0,0x0,0x0,0x0,0x0,0x0,0x0,0x0,0x0,0x0,0x0,0x0,0x0
.long 0x0,0x0,0x0,0x0,0x0,0x0,0x0,0x0,0x0,0x0,0x0,0x0,0x0,0x0,0x0,0x0
.size L_table, 16384
.section .rodata,"a"
.p2align 6
.amdhsa_kernel interleave_layers__spectral_fnet__moe_arch_mod__prompt_kernel
  .amdhsa_next_free_vgpr 256
  .amdhsa_next_free_sgpr 102
  .amdhsa_accum_offset 256
  .amdhsa_group_segment_fixed_size 0
  .amdhsa_kernarg_size 104
  .amdhsa_user_sgpr_count 2
  .amdhsa_user_sgpr_kernarg_segment_ptr 1
  .amdhsa_system_sgpr_workgroup_id_x 1
.end_amdhsa_kernel
```
